```python
import torch

def _softmax(x, axis=-1):
    return torch.softmax(x, dim=axis)
def _gelu(x):
    return torch.nn.functional.gelu(x, approximate="tanh")
def _silu(x):
    return torch.nn.functional.silu(x)
def _sigmoid(x):
    return torch.sigmoid(x)
def _layernorm(x, axis=-1, eps=1e-5):
    m = x.mean(dim=axis, keepdim=True)
    v = x.var(dim=axis, keepdim=True, unbiased=False)
    return (x - m) / torch.sqrt(v + eps)
def _scatter_add(tgt, idx, src, axis=0):
    return tgt.clone().index_add_(axis, idx, src)
def _segment_sum(src, seg, n):
    out = torch.zeros((n,) + src.shape[1:], dtype=src.dtype)
    return out.index_add_(0, seg, src)
def _pad(x, pw):
    flat = tuple(v for pair in reversed(pw) for v in pair)
    return torch.nn.functional.pad(x, flat)

kernel_name = 'recurrent_scan__mha_block_cached__dense_activation_squared_relu__decode'

def setup_inputs():

    _w = (lambda a: (lambda t: t.to(torch.bfloat16) if t.is_floating_point() else t)(torch.as_tensor(a)))
    def _A_setup():
        B, Sq, D = 2, 1, 576
        H, Sk, Dh = 32, 4096, 128
        return {
            "x": _w((lambda *s: torch.randn(*s, dtype=torch.bfloat16) * 0.05)(B, Sq, D)),
            "k_cache": _w((lambda *s: torch.randn(*s, dtype=torch.bfloat16) * 0.8)(B, H, Sk, Dh)),
            "v_cache": _w((lambda *s: torch.randn(*s, dtype=torch.bfloat16) * 0.2)(B, H, Sk, Dh)),
            "wq": _w((lambda *s: torch.randn(*s, dtype=torch.bfloat16) * 0.8)(D, H * Dh) * (D ** -0.5)),
            "wo": _w((lambda *s: torch.randn(*s, dtype=torch.bfloat16) * 0.2)(H * Dh, D) * ((H * Dh) ** -0.5)),
        }
    _A_in = _A_setup()

    def _B_setup():
        B, S, D, F = 2, 1, 576, 4608
        return {
            "x": _w((lambda *s: torch.randn(*s, dtype=torch.bfloat16) * 0.05)(B, S, D)),
            "w1": _w((lambda *s: torch.randn(*s, dtype=torch.bfloat16) * 0.1)(D, F)),
            "b1": _w((lambda *s: torch.randn(*s, dtype=torch.bfloat16) * 0.8)(F)),
            "w2": _w((lambda *s: torch.randn(*s, dtype=torch.bfloat16) * 0.1)(F, D)),
            "b2": _w((lambda *s: torch.randn(*s, dtype=torch.bfloat16) * 12.8)(D)),
        }
    _B_in = _B_setup()

    return {
        "A_x": _A_in["x"],
        "A_k_cache": _A_in["k_cache"],
        "A_v_cache": _A_in["v_cache"],
        "A_wq": _A_in["wq"],
        "A_wo": _A_in["wo"],
        "B_x": _B_in["x"],
        "B_w1": _B_in["w1"],
        "B_b1": _B_in["b1"],
        "B_w2": _B_in["w2"],
        "B_b2": _B_in["b2"],
    }

def reference(A_x, A_k_cache, A_v_cache, A_wq, A_wo, B_x, B_w1, B_b1, B_w2, B_b2):
    def _A_ref(x, k_cache, v_cache, wq, wo):
        B, Sq, D = x.shape
        H, Dh = 32, 128
        q = (lambda x, *d: x.permute(*d))((x @ wq).reshape(B, Sq, H, Dh), 0, 2, 1, 3)
        scores = torch.einsum("bhqd,bhkd->bhqk", q, k_cache) * (Dh ** -0.5)
        p = _softmax(scores, axis=-1)
        o = torch.einsum("bhqk,bhkd->bhqd", p, v_cache)
        return (lambda x, *d: x.permute(*d))(o, 0, 2, 1, 3).reshape(B, Sq, H * Dh) @ wo

    def _B_ref(x, w1, b1, w2, b2):
        h = torch.einsum("bsd,df->bsf", x, w1) + b1
        zero = torch.zeros_like(h)
        r = torch.where(h > zero, h, zero)
        h = r * r
        out = torch.einsum("bsf,fd->bsd", h, w2) + b2
        return out

    x = A_x
    xn = _layernorm(x, axis=-1)
    s = _A_ref(xn, A_k_cache, A_v_cache, A_wq, A_wo)
    g = _silu(_B_ref(xn, B_w1, B_b1, B_w2, B_b2))
    return x + s * g
```

```asm
; @launch grid=(256,1,1) block=(320,1,1) lds=90112
.amdgcn_target "amdgcn-amd-amdhsa--gfx950"
.text
.globl recurrent_scan__mha_block_cached__dense_activation_squared_relu__decode_kernel
.p2align 8
.type recurrent_scan__mha_block_cached__dense_activation_squared_relu__decode_kernel,@function
recurrent_scan__mha_block_cached__dense_activation_squared_relu__decode_kernel:
  s_cmp_ge_u32 s2, 256
  s_cbranch_scc1 L_end
  s_load_dwordx16 s[16:31], s[0:1], 0
  s_load_dwordx8 s[32:39], s[0:1], 64
  s_load_dwordx2 s[40:41], s[0:1], 96
  s_getpc_b64 s[42:43]
L_pc:
  s_lshr_b32 s4, s2, 3
  s_lshl_b32 s4, s4, 10
  v_and_b32 v2, 63, v0
  v_lshlrev_b32 v2, 4, v2
  v_add_u32 v2, s4, v2
  v_min_u32 v2, (L_code_end - L_pc - 16), v2
  global_load_dwordx4 v[4:7], v2, s[42:43]
  v_lshrrev_b32 v1, 6, v0
  v_and_b32 v0, 63, v0
  v_readfirstlane_b32 s3, v1
  s_and_b32 s4, s2, 7
  s_lshr_b32 s5, s2, 3
  s_lshr_b32 s6, s4, 2
  s_and_b32 s7, s4, 3
  s_lshl_b32 s7, s7, 3
  s_lshr_b32 s8, s5, 2
  s_add_u32 s7, s7, s8
  s_and_b32 s8, s5, 3
  s_lshl_b32 s9, s6, 2
  s_add_u32 s9, s9, s8
  s_cmp_lg_u32 s3, 0
  s_cbranch_scc1 L_stream
  s_setprio 3
  v_lshlrev_b32 v14, 2, v0
  v_mov_b32 v16, 0
  v_lshrrev_b32 v15, 4, v0
  v_lshlrev_b32 v15, 13, v15
  v_and_b32 v17, 15, v0
  v_lshlrev_b32 v17, 4, v17
  v_add_u32 v15, v15, v17
  s_mul_i32 s48, s9, 589824
  s_lshl_b32 s49, s7, 8
  s_add_u32 s48, s48, s49
  s_mov_b32 s46, 4718592
  s_mov_b32 s47, 0x00020000
  v_mov_b32 v20, 0
  ds_write_b32 v14, v20 offset:3344
  s_waitcnt lgkmcnt(0)
  global_load_dword v1, v14, s[16:17] offset:0
  global_load_dword v2, v14, s[16:17] offset:256
  global_load_dword v3, v14, s[16:17] offset:512
  global_load_dword v4, v14, s[16:17] offset:768
  global_load_dword v5, v14, s[16:17] offset:1024
  global_load_dword v6, v14, s[16:17] offset:1280
  global_load_dword v7, v14, s[16:17] offset:1536
  global_load_dword v8, v14, s[16:17] offset:1792
  global_load_dword v9, v14, s[16:17] offset:2048
  global_load_dword v10, v16, s[40:41] sc1
  s_mov_b32 s44, s22
  s_mov_b32 s45, s23
  buffer_load_dwordx4 v[152:155], v15, s[44:47], s48 offen nt
  s_add_u32 s48, s48, 32768
  buffer_load_dwordx4 v[156:159], v15, s[44:47], s48 offen nt
  s_add_u32 s48, s48, 32768
  buffer_load_dwordx4 v[160:163], v15, s[44:47], s48 offen nt
  s_add_u32 s48, s48, 32768
  buffer_load_dwordx4 v[164:167], v15, s[44:47], s48 offen nt
  s_add_u32 s48, s48, 32768
  buffer_load_dwordx4 v[168:171], v15, s[44:47], s48 offen nt
  s_add_u32 s48, s48, 32768
  buffer_load_dwordx4 v[172:175], v15, s[44:47], s48 offen nt
  s_add_u32 s48, s48, 32768
  buffer_load_dwordx4 v[176:179], v15, s[44:47], s48 offen nt
  s_add_u32 s48, s48, 32768
  buffer_load_dwordx4 v[180:183], v15, s[44:47], s48 offen nt
  s_add_u32 s48, s48, 32768
  buffer_load_dwordx4 v[184:187], v15, s[44:47], s48 offen nt
  s_add_u32 s48, s48, 32768
  buffer_load_dwordx4 v[188:191], v15, s[44:47], s48 offen nt
  s_add_u32 s48, s48, 32768
  buffer_load_dwordx4 v[192:195], v15, s[44:47], s48 offen nt
  s_add_u32 s48, s48, 32768
  buffer_load_dwordx4 v[196:199], v15, s[44:47], s48 offen nt
  s_add_u32 s48, s48, 32768
  buffer_load_dwordx4 v[200:203], v15, s[44:47], s48 offen nt
  s_add_u32 s48, s48, 32768
  buffer_load_dwordx4 v[204:207], v15, s[44:47], s48 offen nt
  s_add_u32 s48, s48, 32768
  buffer_load_dwordx4 v[208:211], v15, s[44:47], s48 offen nt
  s_add_u32 s48, s48, 32768
  buffer_load_dwordx4 v[212:215], v15, s[44:47], s48 offen nt
  s_add_u32 s48, s48, 32768
  buffer_load_dwordx4 v[216:219], v15, s[44:47], s48 offen nt
  s_add_u32 s48, s48, 32768
  buffer_load_dwordx4 v[220:223], v15, s[44:47], s48 offen nt
  s_barrier
  s_branch L_srv2
L_stream:
  s_sub_u32 s14, s3, 1
  v_lshlrev_b32 v1, 4, v0
  s_lshl_b32 s4, s14, 10
  v_add_u32 v1, s4, v1
  s_mov_b32 s46, 67108864
  s_mov_b32 s47, 0x00020000
  s_lshl_b32 s4, s6, 5
  s_add_u32 s4, s4, s7
  s_lshl_b32 s4, s4, 20
  s_lshr_b32 s5, s8, 1
  s_lshl_b32 s5, s5, 19
  s_add_u32 s4, s4, s5
  s_and_b32 s5, s8, 1
  s_mul_i32 s5, s5, 262144
  s_add_u32 s64, s4, s5
  s_mov_b32 s65, s64
  s_waitcnt lgkmcnt(0)
  s_mov_b32 s44, s18
  s_mov_b32 s45, s19
  buffer_load_dwordx4 v[52:55], v1, s[44:47], s64 offen nt
  s_add_u32 s64, s64, 4096
  buffer_load_dwordx4 v[56:59], v1, s[44:47], s64 offen nt
  s_add_u32 s64, s64, 4096
  buffer_load_dwordx4 v[60:63], v1, s[44:47], s64 offen nt
  s_add_u32 s64, s64, 4096
  buffer_load_dwordx4 v[64:67], v1, s[44:47], s64 offen nt
  s_add_u32 s64, s64, 4096
  s_mul_i32 s10, s7, 7
  s_add_u32 s10, s10, s9
  s_mul_i32 s11, s10, 171
  s_lshr_b32 s11, s11, 9
  s_mul_i32 s12, s11, 3
  s_sub_u32 s12, s10, s12
  s_cmp_lt_u32 s10, 216
  s_cselect_b32 s13, 1, 0
  s_cmp_eq_u32 s9, 7
  s_cselect_b32 s13, 2, s13
  v_lshrrev_b32 v24, 3, v0
  v_and_b32 v25, 7, v0
  v_lshlrev_b32 v25, 4, v25
  v_mul_u32_u24 v2, 9216, v24
  v_add_u32 v2, v2, v25
  v_mul_u32_u24 v3, 1152, v24
  v_add_u32 v3, v3, v25
  s_mov_b32 s50, 67108864
  s_mov_b32 s51, 0x00020000
  s_mov_b32 s54, 5308416
  s_mov_b32 s55, 0x00020000
  s_mov_b32 s58, 5308416
  s_mov_b32 s59, 0x00020000
  s_mov_b32 s62, 4718592
  s_mov_b32 s63, 0x00020000
  s_mul_i32 s66, s7, 147456
  s_lshl_b32 s67, s9, 7
  s_add_u32 s66, s66, s67
  s_mul_i32 s68, s14, 9216
  s_add_u32 s66, s66, s68
  s_lshl_b32 s69, s14, 10
  s_add_u32 s67, s69, 6400
  s_waitcnt lgkmcnt(0)
  s_mov_b32 s44, s18
  s_mov_b32 s45, s19
  s_mov_b32 s48, s20
  s_mov_b32 s49, s21
  s_mov_b32 s52, s28
  s_mov_b32 s53, s29
  s_mov_b32 s56, s32
  s_mov_b32 s57, s33
  s_mov_b32 s60, s24
  s_mov_b32 s61, s25
  s_lshl_b32 s4, s14, 4
  s_add_u32 s4, s4, 3356
  v_mov_b32 v20, s4
  s_barrier
  s_cmp_lg_u32 s13, 1
  s_cbranch_scc1 L_s_not1
  s_mul_i32 s66, s12, 1769472
  s_lshl_b32 s67, s11, 7
  s_add_u32 s66, s66, s67
  s_mul_i32 s67, s14, 73728
  s_add_u32 s66, s66, s67
  s_add_u32 s67, s69, 22784
  s_mov_b32 m0, s67
  s_nop 0
  buffer_load_dwordx4 v2, s[52:55], s66 offen nt lds
  s_add_u32 s66, s66, 294912
  s_add_u32 s67, s67, 4096
  s_mov_b32 m0, s67
  s_nop 0
  buffer_load_dwordx4 v2, s[52:55], s66 offen nt lds
  s_add_u32 s66, s66, 294912
  s_add_u32 s67, s67, 4096
  s_mov_b32 m0, s67
  s_nop 0
  buffer_load_dwordx4 v2, s[52:55], s66 offen nt lds
  s_add_u32 s66, s66, 294912
  s_add_u32 s67, s67, 4096
  s_mov_b32 m0, s67
  s_nop 0
  buffer_load_dwordx4 v2, s[52:55], s66 offen nt lds
  s_add_u32 s66, s66, 294912
  s_add_u32 s67, s67, 4096
  s_waitcnt vmcnt(7)
  s_mov_b32 m0, s67
  s_nop 0
  buffer_load_dwordx4 v2, s[52:55], s66 offen nt lds
  s_add_u32 s66, s66, 294912
  s_add_u32 s67, s67, 4096
  s_waitcnt vmcnt(7)
  s_mov_b32 m0, s67
  s_nop 0
  buffer_load_dwordx4 v2, s[52:55], s66 offen nt lds
  s_branch L_s_k
L_s_not1:
  s_cmp_lg_u32 s13, 2
  s_cbranch_scc1 L_s_k
  s_mul_i32 s66, s7, 147456
  s_add_u32 s66, s66, 1024
  s_mul_i32 s67, s14, 9216
  s_add_u32 s66, s66, s67
  s_add_u32 s67, s69, 22784
  s_waitcnt vmcnt(7)
  s_mov_b32 m0, s67
  s_nop 0
  buffer_load_dwordx4 v3, s[60:63], s66 offen nt lds
  s_add_u32 s66, s66, 36864
  s_add_u32 s67, s67, 4096
  s_waitcnt vmcnt(7)
  s_mov_b32 m0, s67
  s_nop 0
  buffer_load_dwordx4 v3, s[60:63], s66 offen nt lds
  s_add_u32 s66, s66, 36864
  s_add_u32 s67, s67, 4096
  s_waitcnt vmcnt(7)
  s_mov_b32 m0, s67
  s_nop 0
  buffer_load_dwordx4 v3, s[60:63], s66 offen nt lds
  s_add_u32 s66, s66, 36864
  s_add_u32 s67, s67, 4096
  s_waitcnt vmcnt(7)
  s_mov_b32 m0, s67
  s_nop 0
  buffer_load_dwordx4 v3, s[60:63], s66 offen nt lds
L_s_k:
  s_waitcnt vmcnt(7)
  buffer_load_dwordx4 v[68:71], v1, s[44:47], s64 offen nt
  s_add_u32 s64, s64, 4096
  s_waitcnt vmcnt(7)
  buffer_load_dwordx4 v[72:75], v1, s[44:47], s64 offen nt
  s_add_u32 s64, s64, 4096
  s_waitcnt vmcnt(7)
  buffer_load_dwordx4 v[76:79], v1, s[44:47], s64 offen nt
  s_add_u32 s64, s64, 4096
  s_mov_b32 s26, 0x07060503
  s_mov_b32 s27, 0x07060502
  s_mov_b32 s38, 0x07060501
  s_mov_b32 s39, 0x04000c0c
  s_mov_b32 s15, 0x0706000c
  v_and_b32 v24, 15, v0
  v_and_b32 v25, 1, v0
  v_lshlrev_b32 v25, 4, v25
  v_mov_b32 v26, 0xffff
  v_lshlrev_b32 v26, v25, v26
  v_lshrrev_b32 v27, 1, v24
  v_cmp_eq_u32 vcc, 0, v27
  s_nop 1
  v_cndmask_b32 v8, 0, v26, vcc
  v_cmp_eq_u32 vcc, 1, v27
  s_nop 1
  v_cndmask_b32 v9, 0, v26, vcc
  v_cmp_eq_u32 vcc, 2, v27
  s_nop 1
  v_cndmask_b32 v10, 0, v26, vcc
  v_cmp_eq_u32 vcc, 3, v27
  s_nop 1
  v_cndmask_b32 v11, 0, v26, vcc
  v_lshrrev_b32 v24, 4, v0
  v_lshlrev_b32 v24, 5, v24
  v_and_b32 v25, 7, v0
  v_add_u32 v24, v24, v25
  v_lshlrev_b32 v24, 2, v24
  s_lshl_b32 s4, s14, 9
  s_add_u32 s4, s4, 3600
  v_add_u32 v17, s4, v24
  v_and_b32 v24, 3, v0
  v_lshlrev_b32 v25, 8, v24
  v_add_u32 v25, 5648, v25
  v_cmp_gt_u32 vcc, 2, v24
  v_mov_b32 v26, 2304
  s_nop 0
  v_cndmask_b32 v25, v26, v25, vcc
  v_lshrrev_b32 v26, 4, v0
  v_lshlrev_b32 v26, 4, v26
  v_add_u32 v18, v25, v26
  s_mul_i32 s4, s7, 4608
  s_lshl_b32 s5, s9, 9
  s_add_u32 s4, s4, s5
  s_lshl_b32 s5, s14, 7
  s_add_u32 s4, s4, s5
  s_add_u32 s4, s4, 1179648
  v_lshrrev_b32 v19, 1, v0
  v_lshlrev_b32 v19, 4, v19
  v_add_u32 v19, s4, v19
  v_mov_b32 v13, 0xff800000
  s_mov_b32 s70, 0x3fb8aa3b
  s_mov_b32 s71, 0x3db504f3
  s_waitcnt vmcnt(7)
  buffer_load_dwordx4 v[80:83], v1, s[44:47], s64 offen nt
  s_add_u32 s64, s64, 4096
  s_waitcnt vmcnt(7)
  buffer_load_dwordx4 v[84:87], v1, s[44:47], s64 offen nt
  s_add_u32 s64, s64, 4096
  s_waitcnt vmcnt(7)
  buffer_load_dwordx4 v[88:91], v1, s[44:47], s64 offen nt
  s_add_u32 s64, s64, 4096
  s_waitcnt vmcnt(7)
  buffer_load_dwordx4 v[92:95], v1, s[44:47], s64 offen nt
  s_add_u32 s64, s64, 4096
  s_waitcnt vmcnt(7)
  buffer_load_dwordx4 v[96:99], v1, s[44:47], s64 offen nt
  s_add_u32 s64, s64, 4096
  s_waitcnt vmcnt(7)
  v_mov_b32 v30, 1
  s_mov_b64 exec, 1
  ds_write_b32 v20, v30
  s_mov_b64 exec, -1
  buffer_load_dwordx4 v[100:103], v1, s[44:47], s64 offen nt
  s_add_u32 s64, s64, 4096
  s_waitcnt vmcnt(7)
  buffer_load_dwordx4 v[104:107], v1, s[44:47], s64 offen nt
  s_add_u32 s64, s64, 4096
  s_waitcnt vmcnt(7)
  v_mov_b32 v30, 2
  s_mov_b64 exec, 1
  ds_write_b32 v20, v30
  s_mov_b64 exec, -1
  buffer_load_dwordx4 v[108:111], v1, s[44:47], s64 offen nt
  s_add_u32 s64, s64, 4096
  s_waitcnt vmcnt(7)
  buffer_load_dwordx4 v[112:115], v1, s[44:47], s64 offen nt
  s_add_u32 s64, s64, 4096
  s_waitcnt vmcnt(7)
  buffer_load_dwordx4 v[116:119], v1, s[44:47], s64 offen nt
  s_add_u32 s64, s64, 4096
  s_waitcnt vmcnt(7)
  buffer_load_dwordx4 v[120:123], v1, s[44:47], s64 offen nt
  s_add_u32 s64, s64, 4096
  s_waitcnt vmcnt(7)
  buffer_load_dwordx4 v[124:127], v1, s[44:47], s64 offen nt
  s_add_u32 s64, s64, 4096
  s_waitcnt vmcnt(7)
  buffer_load_dwordx4 v[128:131], v1, s[44:47], s64 offen nt
  s_add_u32 s64, s64, 4096
  s_waitcnt vmcnt(7)
  buffer_load_dwordx4 v[132:135], v1, s[44:47], s64 offen nt
  s_add_u32 s64, s64, 4096
  s_waitcnt vmcnt(7)
  buffer_load_dwordx4 v[136:139], v1, s[44:47], s64 offen nt
  s_add_u32 s64, s64, 4096
  s_waitcnt vmcnt(7)
  buffer_load_dwordx4 v[140:143], v1, s[44:47], s64 offen nt
  s_add_u32 s64, s64, 4096
  s_waitcnt vmcnt(7)
  buffer_load_dwordx4 v[144:147], v1, s[44:47], s64 offen nt
  s_add_u32 s64, s64, 4096
  s_waitcnt vmcnt(7)
  buffer_load_dwordx4 v[148:151], v1, s[44:47], s64 offen nt
  s_add_u32 s64, s64, 4096
  s_waitcnt vmcnt(7)
  buffer_load_dwordx4 v[152:155], v1, s[44:47], s64 offen nt
  s_add_u32 s64, s64, 4096
  s_waitcnt vmcnt(7)
  buffer_load_dwordx4 v[156:159], v1, s[44:47], s64 offen nt
  s_add_u32 s64, s64, 4096
  s_waitcnt vmcnt(7)
  buffer_load_dwordx4 v[160:163], v1, s[44:47], s64 offen nt
  s_add_u32 s64, s64, 4096
  s_waitcnt vmcnt(7)
  buffer_load_dwordx4 v[164:167], v1, s[44:47], s64 offen nt
  s_add_u32 s64, s64, 4096
  s_waitcnt vmcnt(7)
  buffer_load_dwordx4 v[168:171], v1, s[44:47], s64 offen nt
  s_add_u32 s64, s64, 4096
  s_waitcnt vmcnt(7)
  buffer_load_dwordx4 v[172:175], v1, s[44:47], s64 offen nt
  s_add_u32 s64, s64, 4096
  s_waitcnt vmcnt(7)
  buffer_load_dwordx4 v[176:179], v1, s[44:47], s64 offen nt
  s_add_u32 s64, s64, 4096
  s_barrier
  v_and_b32 v24, 15, v0
  v_lshlrev_b32 v24, 4, v24
  ds_read_b128 v[4:7], v24 offset:3072
  v_mov_b32 v25, 3328
  ds_read_b32 v12, v25
  s_waitcnt lgkmcnt(0)
  s_waitcnt vmcnt(28)
  v_dot2_f32_bf16 v180, v52, v4, 0
  v_dot2_f32_bf16 v181, v56, v4, 0
  v_dot2_f32_bf16 v182, v60, v4, 0
  v_dot2_f32_bf16 v183, v64, v4, 0
  v_dot2_f32_bf16 v180, v53, v5, v180
  v_dot2_f32_bf16 v181, v57, v5, v181
  v_dot2_f32_bf16 v182, v61, v5, v182
  v_dot2_f32_bf16 v183, v65, v5, v183
  v_dot2_f32_bf16 v180, v54, v6, v180
  v_dot2_f32_bf16 v181, v58, v6, v181
  v_dot2_f32_bf16 v182, v62, v6, v182
  v_dot2_f32_bf16 v183, v66, v6, v183
  v_dot2_f32_bf16 v180, v55, v7, v180
  v_dot2_f32_bf16 v181, v59, v7, v181
  v_dot2_f32_bf16 v182, v63, v7, v182
  v_dot2_f32_bf16 v183, v67, v7, v183
  v_add_f32_dpp v180, v180, v180 row_ror:8 row_mask:0xf bank_mask:0xf
  v_add_f32_dpp v181, v181, v181 row_ror:8 row_mask:0xf bank_mask:0xf
  v_add_f32_dpp v182, v182, v182 row_ror:8 row_mask:0xf bank_mask:0xf
  v_add_f32_dpp v183, v183, v183 row_ror:8 row_mask:0xf bank_mask:0xf
  v_add_f32_dpp v180, v180, v180 row_ror:4 row_mask:0xf bank_mask:0xf
  v_add_f32_dpp v181, v181, v181 row_ror:4 row_mask:0xf bank_mask:0xf
  v_add_f32_dpp v182, v182, v182 row_ror:4 row_mask:0xf bank_mask:0xf
  v_add_f32_dpp v183, v183, v183 row_ror:4 row_mask:0xf bank_mask:0xf
  v_add_f32_dpp v180, v180, v180 row_ror:2 row_mask:0xf bank_mask:0xf
  v_add_f32_dpp v181, v181, v181 row_ror:2 row_mask:0xf bank_mask:0xf
  v_add_f32_dpp v182, v182, v182 row_ror:2 row_mask:0xf bank_mask:0xf
  v_add_f32_dpp v183, v183, v183 row_ror:2 row_mask:0xf bank_mask:0xf
  v_add_f32_dpp v180, v180, v180 row_ror:1 row_mask:0xf bank_mask:0xf
  v_add_f32_dpp v181, v181, v181 row_ror:1 row_mask:0xf bank_mask:0xf
  v_add_f32_dpp v182, v182, v182 row_ror:1 row_mask:0xf bank_mask:0xf
  v_add_f32_dpp v183, v183, v183 row_ror:1 row_mask:0xf bank_mask:0xf
  v_cvt_pk_bf16_f32 v24, v180, v181
  v_cvt_pk_bf16_f32 v25, v182, v183
  v_lshlrev_b32 v180, 16, v24
  v_and_b32 v181, 0xffff0000, v24
  v_lshlrev_b32 v182, 16, v25
  v_and_b32 v183, 0xffff0000, v25
  v_mul_f32 v180, s71, v180
  v_mul_f32 v181, s71, v181
  v_mul_f32 v182, s71, v182
  v_mul_f32 v183, s71, v183
  v_cvt_pk_bf16_f32 v24, v180, v181
  v_cvt_pk_bf16_f32 v25, v182, v183
  v_lshlrev_b32 v180, 16, v24
  v_and_b32 v181, 0xffff0000, v24
  v_lshlrev_b32 v182, 16, v25
  v_and_b32 v183, 0xffff0000, v25
  v_max3_f32 v13, v13, v180, v181
  v_max3_f32 v13, v13, v182, v183
  s_waitcnt vmcnt(24)
  v_dot2_f32_bf16 v184, v68, v4, 0
  v_dot2_f32_bf16 v185, v72, v4, 0
  v_dot2_f32_bf16 v186, v76, v4, 0
  v_dot2_f32_bf16 v187, v80, v4, 0
  v_dot2_f32_bf16 v184, v69, v5, v184
  v_dot2_f32_bf16 v185, v73, v5, v185
  v_dot2_f32_bf16 v186, v77, v5, v186
  v_dot2_f32_bf16 v187, v81, v5, v187
  v_dot2_f32_bf16 v184, v70, v6, v184
  v_dot2_f32_bf16 v185, v74, v6, v185
  v_dot2_f32_bf16 v186, v78, v6, v186
  v_dot2_f32_bf16 v187, v82, v6, v187
  v_dot2_f32_bf16 v184, v71, v7, v184
  v_dot2_f32_bf16 v185, v75, v7, v185
  v_dot2_f32_bf16 v186, v79, v7, v186
  v_dot2_f32_bf16 v187, v83, v7, v187
  v_add_f32_dpp v184, v184, v184 row_ror:8 row_mask:0xf bank_mask:0xf
  v_add_f32_dpp v185, v185, v185 row_ror:8 row_mask:0xf bank_mask:0xf
  v_add_f32_dpp v186, v186, v186 row_ror:8 row_mask:0xf bank_mask:0xf
  v_add_f32_dpp v187, v187, v187 row_ror:8 row_mask:0xf bank_mask:0xf
  v_add_f32_dpp v184, v184, v184 row_ror:4 row_mask:0xf bank_mask:0xf
  v_add_f32_dpp v185, v185, v185 row_ror:4 row_mask:0xf bank_mask:0xf
  v_add_f32_dpp v186, v186, v186 row_ror:4 row_mask:0xf bank_mask:0xf
  v_add_f32_dpp v187, v187, v187 row_ror:4 row_mask:0xf bank_mask:0xf
  v_add_f32_dpp v184, v184, v184 row_ror:2 row_mask:0xf bank_mask:0xf
  v_add_f32_dpp v185, v185, v185 row_ror:2 row_mask:0xf bank_mask:0xf
  v_add_f32_dpp v186, v186, v186 row_ror:2 row_mask:0xf bank_mask:0xf
  v_add_f32_dpp v187, v187, v187 row_ror:2 row_mask:0xf bank_mask:0xf
  v_add_f32_dpp v184, v184, v184 row_ror:1 row_mask:0xf bank_mask:0xf
  v_add_f32_dpp v185, v185, v185 row_ror:1 row_mask:0xf bank_mask:0xf
  v_add_f32_dpp v186, v186, v186 row_ror:1 row_mask:0xf bank_mask:0xf
  v_add_f32_dpp v187, v187, v187 row_ror:1 row_mask:0xf bank_mask:0xf
  v_cvt_pk_bf16_f32 v24, v184, v185
  v_cvt_pk_bf16_f32 v25, v186, v187
  v_lshlrev_b32 v184, 16, v24
  v_and_b32 v185, 0xffff0000, v24
  v_lshlrev_b32 v186, 16, v25
  v_and_b32 v187, 0xffff0000, v25
  v_mul_f32 v184, s71, v184
  v_mul_f32 v185, s71, v185
  v_mul_f32 v186, s71, v186
  v_mul_f32 v187, s71, v187
  v_cvt_pk_bf16_f32 v24, v184, v185
  v_cvt_pk_bf16_f32 v25, v186, v187
  v_lshlrev_b32 v184, 16, v24
  v_and_b32 v185, 0xffff0000, v24
  v_lshlrev_b32 v186, 16, v25
  v_and_b32 v187, 0xffff0000, v25
  v_max3_f32 v13, v13, v184, v185
  v_max3_f32 v13, v13, v186, v187
  s_waitcnt vmcnt(20)
  v_dot2_f32_bf16 v188, v84, v4, 0
  v_dot2_f32_bf16 v189, v88, v4, 0
  v_dot2_f32_bf16 v190, v92, v4, 0
  v_dot2_f32_bf16 v191, v96, v4, 0
  v_dot2_f32_bf16 v188, v85, v5, v188
  v_dot2_f32_bf16 v189, v89, v5, v189
  v_dot2_f32_bf16 v190, v93, v5, v190
  v_dot2_f32_bf16 v191, v97, v5, v191
  v_dot2_f32_bf16 v188, v86, v6, v188
  v_dot2_f32_bf16 v189, v90, v6, v189
  v_dot2_f32_bf16 v190, v94, v6, v190
  v_dot2_f32_bf16 v191, v98, v6, v191
  v_dot2_f32_bf16 v188, v87, v7, v188
  v_dot2_f32_bf16 v189, v91, v7, v189
  v_dot2_f32_bf16 v190, v95, v7, v190
  v_dot2_f32_bf16 v191, v99, v7, v191
  v_add_f32_dpp v188, v188, v188 row_ror:8 row_mask:0xf bank_mask:0xf
  v_add_f32_dpp v189, v189, v189 row_ror:8 row_mask:0xf bank_mask:0xf
  v_add_f32_dpp v190, v190, v190 row_ror:8 row_mask:0xf bank_mask:0xf
  v_add_f32_dpp v191, v191, v191 row_ror:8 row_mask:0xf bank_mask:0xf
  v_add_f32_dpp v188, v188, v188 row_ror:4 row_mask:0xf bank_mask:0xf
  v_add_f32_dpp v189, v189, v189 row_ror:4 row_mask:0xf bank_mask:0xf
  v_add_f32_dpp v190, v190, v190 row_ror:4 row_mask:0xf bank_mask:0xf
  v_add_f32_dpp v191, v191, v191 row_ror:4 row_mask:0xf bank_mask:0xf
  v_add_f32_dpp v188, v188, v188 row_ror:2 row_mask:0xf bank_mask:0xf
  v_add_f32_dpp v189, v189, v189 row_ror:2 row_mask:0xf bank_mask:0xf
  v_add_f32_dpp v190, v190, v190 row_ror:2 row_mask:0xf bank_mask:0xf
  v_add_f32_dpp v191, v191, v191 row_ror:2 row_mask:0xf bank_mask:0xf
  v_add_f32_dpp v188, v188, v188 row_ror:1 row_mask:0xf bank_mask:0xf
  v_add_f32_dpp v189, v189, v189 row_ror:1 row_mask:0xf bank_mask:0xf
  v_add_f32_dpp v190, v190, v190 row_ror:1 row_mask:0xf bank_mask:0xf
  v_add_f32_dpp v191, v191, v191 row_ror:1 row_mask:0xf bank_mask:0xf
  v_cvt_pk_bf16_f32 v24, v188, v189
  v_cvt_pk_bf16_f32 v25, v190, v191
  v_lshlrev_b32 v188, 16, v24
  v_and_b32 v189, 0xffff0000, v24
  v_lshlrev_b32 v190, 16, v25
  v_and_b32 v191, 0xffff0000, v25
  v_mul_f32 v188, s71, v188
  v_mul_f32 v189, s71, v189
  v_mul_f32 v190, s71, v190
  v_mul_f32 v191, s71, v191
  v_cvt_pk_bf16_f32 v24, v188, v189
  v_cvt_pk_bf16_f32 v25, v190, v191
  v_lshlrev_b32 v188, 16, v24
  v_and_b32 v189, 0xffff0000, v24
  v_lshlrev_b32 v190, 16, v25
  v_and_b32 v191, 0xffff0000, v25
  v_max3_f32 v13, v13, v188, v189
  v_max3_f32 v13, v13, v190, v191
  s_waitcnt vmcnt(16)
  v_dot2_f32_bf16 v192, v100, v4, 0
  v_dot2_f32_bf16 v193, v104, v4, 0
  v_dot2_f32_bf16 v194, v108, v4, 0
  v_dot2_f32_bf16 v195, v112, v4, 0
  v_dot2_f32_bf16 v192, v101, v5, v192
  v_dot2_f32_bf16 v193, v105, v5, v193
  v_dot2_f32_bf16 v194, v109, v5, v194
  v_dot2_f32_bf16 v195, v113, v5, v195
  v_dot2_f32_bf16 v192, v102, v6, v192
  v_dot2_f32_bf16 v193, v106, v6, v193
  v_dot2_f32_bf16 v194, v110, v6, v194
  v_dot2_f32_bf16 v195, v114, v6, v195
  v_dot2_f32_bf16 v192, v103, v7, v192
  v_dot2_f32_bf16 v193, v107, v7, v193
  v_dot2_f32_bf16 v194, v111, v7, v194
  v_dot2_f32_bf16 v195, v115, v7, v195
  v_add_f32_dpp v192, v192, v192 row_ror:8 row_mask:0xf bank_mask:0xf
  v_add_f32_dpp v193, v193, v193 row_ror:8 row_mask:0xf bank_mask:0xf
  v_add_f32_dpp v194, v194, v194 row_ror:8 row_mask:0xf bank_mask:0xf
  v_add_f32_dpp v195, v195, v195 row_ror:8 row_mask:0xf bank_mask:0xf
  v_add_f32_dpp v192, v192, v192 row_ror:4 row_mask:0xf bank_mask:0xf
  v_add_f32_dpp v193, v193, v193 row_ror:4 row_mask:0xf bank_mask:0xf
  v_add_f32_dpp v194, v194, v194 row_ror:4 row_mask:0xf bank_mask:0xf
  v_add_f32_dpp v195, v195, v195 row_ror:4 row_mask:0xf bank_mask:0xf
  v_add_f32_dpp v192, v192, v192 row_ror:2 row_mask:0xf bank_mask:0xf
  v_add_f32_dpp v193, v193, v193 row_ror:2 row_mask:0xf bank_mask:0xf
  v_add_f32_dpp v194, v194, v194 row_ror:2 row_mask:0xf bank_mask:0xf
  v_add_f32_dpp v195, v195, v195 row_ror:2 row_mask:0xf bank_mask:0xf
  v_add_f32_dpp v192, v192, v192 row_ror:1 row_mask:0xf bank_mask:0xf
  v_add_f32_dpp v193, v193, v193 row_ror:1 row_mask:0xf bank_mask:0xf
  v_add_f32_dpp v194, v194, v194 row_ror:1 row_mask:0xf bank_mask:0xf
  v_add_f32_dpp v195, v195, v195 row_ror:1 row_mask:0xf bank_mask:0xf
  v_cvt_pk_bf16_f32 v24, v192, v193
  v_cvt_pk_bf16_f32 v25, v194, v195
  v_lshlrev_b32 v192, 16, v24
  v_and_b32 v193, 0xffff0000, v24
  v_lshlrev_b32 v194, 16, v25
  v_and_b32 v195, 0xffff0000, v25
  v_mul_f32 v192, s71, v192
  v_mul_f32 v193, s71, v193
  v_mul_f32 v194, s71, v194
  v_mul_f32 v195, s71, v195
  v_cvt_pk_bf16_f32 v24, v192, v193
  v_cvt_pk_bf16_f32 v25, v194, v195
  v_lshlrev_b32 v192, 16, v24
  v_and_b32 v193, 0xffff0000, v24
  v_lshlrev_b32 v194, 16, v25
  v_and_b32 v195, 0xffff0000, v25
  v_max3_f32 v13, v13, v192, v193
  v_max3_f32 v13, v13, v194, v195
  s_waitcnt vmcnt(12)
  v_dot2_f32_bf16 v196, v116, v4, 0
  v_dot2_f32_bf16 v197, v120, v4, 0
  v_dot2_f32_bf16 v198, v124, v4, 0
  v_dot2_f32_bf16 v199, v128, v4, 0
  v_dot2_f32_bf16 v196, v117, v5, v196
  v_dot2_f32_bf16 v197, v121, v5, v197
  v_dot2_f32_bf16 v198, v125, v5, v198
  v_dot2_f32_bf16 v199, v129, v5, v199
  v_dot2_f32_bf16 v196, v118, v6, v196
  v_dot2_f32_bf16 v197, v122, v6, v197
  v_dot2_f32_bf16 v198, v126, v6, v198
  v_dot2_f32_bf16 v199, v130, v6, v199
  v_dot2_f32_bf16 v196, v119, v7, v196
  v_dot2_f32_bf16 v197, v123, v7, v197
  v_dot2_f32_bf16 v198, v127, v7, v198
  v_dot2_f32_bf16 v199, v131, v7, v199
  v_add_f32_dpp v196, v196, v196 row_ror:8 row_mask:0xf bank_mask:0xf
  v_add_f32_dpp v197, v197, v197 row_ror:8 row_mask:0xf bank_mask:0xf
  v_add_f32_dpp v198, v198, v198 row_ror:8 row_mask:0xf bank_mask:0xf
  v_add_f32_dpp v199, v199, v199 row_ror:8 row_mask:0xf bank_mask:0xf
  v_add_f32_dpp v196, v196, v196 row_ror:4 row_mask:0xf bank_mask:0xf
  v_add_f32_dpp v197, v197, v197 row_ror:4 row_mask:0xf bank_mask:0xf
  v_add_f32_dpp v198, v198, v198 row_ror:4 row_mask:0xf bank_mask:0xf
  v_add_f32_dpp v199, v199, v199 row_ror:4 row_mask:0xf bank_mask:0xf
  v_add_f32_dpp v196, v196, v196 row_ror:2 row_mask:0xf bank_mask:0xf
  v_add_f32_dpp v197, v197, v197 row_ror:2 row_mask:0xf bank_mask:0xf
  v_add_f32_dpp v198, v198, v198 row_ror:2 row_mask:0xf bank_mask:0xf
  v_add_f32_dpp v199, v199, v199 row_ror:2 row_mask:0xf bank_mask:0xf
  v_add_f32_dpp v196, v196, v196 row_ror:1 row_mask:0xf bank_mask:0xf
  v_add_f32_dpp v197, v197, v197 row_ror:1 row_mask:0xf bank_mask:0xf
  v_add_f32_dpp v198, v198, v198 row_ror:1 row_mask:0xf bank_mask:0xf
  v_add_f32_dpp v199, v199, v199 row_ror:1 row_mask:0xf bank_mask:0xf
  v_cvt_pk_bf16_f32 v24, v196, v197
  v_cvt_pk_bf16_f32 v25, v198, v199
  v_lshlrev_b32 v196, 16, v24
  v_and_b32 v197, 0xffff0000, v24
  v_lshlrev_b32 v198, 16, v25
  v_and_b32 v199, 0xffff0000, v25
  v_mul_f32 v196, s71, v196
  v_mul_f32 v197, s71, v197
  v_mul_f32 v198, s71, v198
  v_mul_f32 v199, s71, v199
  v_cvt_pk_bf16_f32 v24, v196, v197
  v_cvt_pk_bf16_f32 v25, v198, v199
  v_lshlrev_b32 v196, 16, v24
  v_and_b32 v197, 0xffff0000, v24
  v_lshlrev_b32 v198, 16, v25
  v_and_b32 v199, 0xffff0000, v25
  v_max3_f32 v13, v13, v196, v197
  v_max3_f32 v13, v13, v198, v199
  s_waitcnt vmcnt(8)
  v_dot2_f32_bf16 v200, v132, v4, 0
  v_dot2_f32_bf16 v201, v136, v4, 0
  v_dot2_f32_bf16 v202, v140, v4, 0
  v_dot2_f32_bf16 v203, v144, v4, 0
  v_dot2_f32_bf16 v200, v133, v5, v200
  v_dot2_f32_bf16 v201, v137, v5, v201
  v_dot2_f32_bf16 v202, v141, v5, v202
  v_dot2_f32_bf16 v203, v145, v5, v203
  v_dot2_f32_bf16 v200, v134, v6, v200
  v_dot2_f32_bf16 v201, v138, v6, v201
  v_dot2_f32_bf16 v202, v142, v6, v202
  v_dot2_f32_bf16 v203, v146, v6, v203
  v_dot2_f32_bf16 v200, v135, v7, v200
  v_dot2_f32_bf16 v201, v139, v7, v201
  v_dot2_f32_bf16 v202, v143, v7, v202
  v_dot2_f32_bf16 v203, v147, v7, v203
  v_add_f32_dpp v200, v200, v200 row_ror:8 row_mask:0xf bank_mask:0xf
  v_add_f32_dpp v201, v201, v201 row_ror:8 row_mask:0xf bank_mask:0xf
  v_add_f32_dpp v202, v202, v202 row_ror:8 row_mask:0xf bank_mask:0xf
  v_add_f32_dpp v203, v203, v203 row_ror:8 row_mask:0xf bank_mask:0xf
  v_add_f32_dpp v200, v200, v200 row_ror:4 row_mask:0xf bank_mask:0xf
  v_add_f32_dpp v201, v201, v201 row_ror:4 row_mask:0xf bank_mask:0xf
  v_add_f32_dpp v202, v202, v202 row_ror:4 row_mask:0xf bank_mask:0xf
  v_add_f32_dpp v203, v203, v203 row_ror:4 row_mask:0xf bank_mask:0xf
  v_add_f32_dpp v200, v200, v200 row_ror:2 row_mask:0xf bank_mask:0xf
  v_add_f32_dpp v201, v201, v201 row_ror:2 row_mask:0xf bank_mask:0xf
  v_add_f32_dpp v202, v202, v202 row_ror:2 row_mask:0xf bank_mask:0xf
  v_add_f32_dpp v203, v203, v203 row_ror:2 row_mask:0xf bank_mask:0xf
  v_add_f32_dpp v200, v200, v200 row_ror:1 row_mask:0xf bank_mask:0xf
  v_add_f32_dpp v201, v201, v201 row_ror:1 row_mask:0xf bank_mask:0xf
  v_add_f32_dpp v202, v202, v202 row_ror:1 row_mask:0xf bank_mask:0xf
  v_add_f32_dpp v203, v203, v203 row_ror:1 row_mask:0xf bank_mask:0xf
  v_cvt_pk_bf16_f32 v24, v200, v201
  v_cvt_pk_bf16_f32 v25, v202, v203
  v_lshlrev_b32 v200, 16, v24
  v_and_b32 v201, 0xffff0000, v24
  v_lshlrev_b32 v202, 16, v25
  v_and_b32 v203, 0xffff0000, v25
  v_mul_f32 v200, s71, v200
  v_mul_f32 v201, s71, v201
  v_mul_f32 v202, s71, v202
  v_mul_f32 v203, s71, v203
  v_cvt_pk_bf16_f32 v24, v200, v201
  v_cvt_pk_bf16_f32 v25, v202, v203
  v_lshlrev_b32 v200, 16, v24
  v_and_b32 v201, 0xffff0000, v24
  v_lshlrev_b32 v202, 16, v25
  v_and_b32 v203, 0xffff0000, v25
  v_max3_f32 v13, v13, v200, v201
  v_max3_f32 v13, v13, v202, v203
  s_waitcnt vmcnt(4)
  buffer_load_dwordx4 v[52:55], v1, s[44:47], s64 offen nt
  s_add_u32 s64, s64, 4096
  buffer_load_dwordx4 v[56:59], v1, s[44:47], s64 offen nt
  s_add_u32 s64, s64, 4096
  buffer_load_dwordx4 v[60:63], v1, s[44:47], s64 offen nt
  s_add_u32 s64, s64, 4096
  buffer_load_dwordx4 v[64:67], v1, s[44:47], s64 offen nt
  s_add_u32 s64, s64, 4096
  v_dot2_f32_bf16 v204, v148, v4, 0
  v_dot2_f32_bf16 v205, v152, v4, 0
  v_dot2_f32_bf16 v206, v156, v4, 0
  v_dot2_f32_bf16 v207, v160, v4, 0
  v_dot2_f32_bf16 v204, v149, v5, v204
  v_dot2_f32_bf16 v205, v153, v5, v205
  v_dot2_f32_bf16 v206, v157, v5, v206
  v_dot2_f32_bf16 v207, v161, v5, v207
  v_dot2_f32_bf16 v204, v150, v6, v204
  v_dot2_f32_bf16 v205, v154, v6, v205
  v_dot2_f32_bf16 v206, v158, v6, v206
  v_dot2_f32_bf16 v207, v162, v6, v207
  v_dot2_f32_bf16 v204, v151, v7, v204
  v_dot2_f32_bf16 v205, v155, v7, v205
  v_dot2_f32_bf16 v206, v159, v7, v206
  v_dot2_f32_bf16 v207, v163, v7, v207
  v_add_f32_dpp v204, v204, v204 row_ror:8 row_mask:0xf bank_mask:0xf
  v_add_f32_dpp v205, v205, v205 row_ror:8 row_mask:0xf bank_mask:0xf
  v_add_f32_dpp v206, v206, v206 row_ror:8 row_mask:0xf bank_mask:0xf
  v_add_f32_dpp v207, v207, v207 row_ror:8 row_mask:0xf bank_mask:0xf
  v_add_f32_dpp v204, v204, v204 row_ror:4 row_mask:0xf bank_mask:0xf
  v_add_f32_dpp v205, v205, v205 row_ror:4 row_mask:0xf bank_mask:0xf
  v_add_f32_dpp v206, v206, v206 row_ror:4 row_mask:0xf bank_mask:0xf
  v_add_f32_dpp v207, v207, v207 row_ror:4 row_mask:0xf bank_mask:0xf
  v_add_f32_dpp v204, v204, v204 row_ror:2 row_mask:0xf bank_mask:0xf
  v_add_f32_dpp v205, v205, v205 row_ror:2 row_mask:0xf bank_mask:0xf
  v_add_f32_dpp v206, v206, v206 row_ror:2 row_mask:0xf bank_mask:0xf
  v_add_f32_dpp v207, v207, v207 row_ror:2 row_mask:0xf bank_mask:0xf
  v_add_f32_dpp v204, v204, v204 row_ror:1 row_mask:0xf bank_mask:0xf
  v_add_f32_dpp v205, v205, v205 row_ror:1 row_mask:0xf bank_mask:0xf
  v_add_f32_dpp v206, v206, v206 row_ror:1 row_mask:0xf bank_mask:0xf
  v_add_f32_dpp v207, v207, v207 row_ror:1 row_mask:0xf bank_mask:0xf
  v_cvt_pk_bf16_f32 v24, v204, v205
  v_cvt_pk_bf16_f32 v25, v206, v207
  v_lshlrev_b32 v204, 16, v24
  v_and_b32 v205, 0xffff0000, v24
  v_lshlrev_b32 v206, 16, v25
  v_and_b32 v207, 0xffff0000, v25
  v_mul_f32 v204, s71, v204
  v_mul_f32 v205, s71, v205
  v_mul_f32 v206, s71, v206
  v_mul_f32 v207, s71, v207
  v_cvt_pk_bf16_f32 v24, v204, v205
  v_cvt_pk_bf16_f32 v25, v206, v207
  v_lshlrev_b32 v204, 16, v24
  v_and_b32 v205, 0xffff0000, v24
  v_lshlrev_b32 v206, 16, v25
  v_and_b32 v207, 0xffff0000, v25
  v_max3_f32 v13, v13, v204, v205
  v_max3_f32 v13, v13, v206, v207
  s_waitcnt vmcnt(4)
  buffer_load_dwordx4 v[68:71], v1, s[44:47], s64 offen nt
  s_add_u32 s64, s64, 4096
  buffer_load_dwordx4 v[72:75], v1, s[44:47], s64 offen nt
  s_add_u32 s64, s64, 4096
  buffer_load_dwordx4 v[76:79], v1, s[44:47], s64 offen nt
  s_add_u32 s64, s64, 4096
  buffer_load_dwordx4 v[80:83], v1, s[44:47], s64 offen nt
  s_add_u32 s64, s64, 4096
  v_dot2_f32_bf16 v208, v164, v4, 0
  v_dot2_f32_bf16 v209, v168, v4, 0
  v_dot2_f32_bf16 v210, v172, v4, 0
  v_dot2_f32_bf16 v211, v176, v4, 0
  v_dot2_f32_bf16 v208, v165, v5, v208
  v_dot2_f32_bf16 v209, v169, v5, v209
  v_dot2_f32_bf16 v210, v173, v5, v210
  v_dot2_f32_bf16 v211, v177, v5, v211
  v_dot2_f32_bf16 v208, v166, v6, v208
  v_dot2_f32_bf16 v209, v170, v6, v209
  v_dot2_f32_bf16 v210, v174, v6, v210
  v_dot2_f32_bf16 v211, v178, v6, v211
  v_dot2_f32_bf16 v208, v167, v7, v208
  v_dot2_f32_bf16 v209, v171, v7, v209
  v_dot2_f32_bf16 v210, v175, v7, v210
  v_dot2_f32_bf16 v211, v179, v7, v211
  v_add_f32_dpp v208, v208, v208 row_ror:8 row_mask:0xf bank_mask:0xf
  v_add_f32_dpp v209, v209, v209 row_ror:8 row_mask:0xf bank_mask:0xf
  v_add_f32_dpp v210, v210, v210 row_ror:8 row_mask:0xf bank_mask:0xf
  v_add_f32_dpp v211, v211, v211 row_ror:8 row_mask:0xf bank_mask:0xf
  v_add_f32_dpp v208, v208, v208 row_ror:4 row_mask:0xf bank_mask:0xf
  v_add_f32_dpp v209, v209, v209 row_ror:4 row_mask:0xf bank_mask:0xf
  v_add_f32_dpp v210, v210, v210 row_ror:4 row_mask:0xf bank_mask:0xf
  v_add_f32_dpp v211, v211, v211 row_ror:4 row_mask:0xf bank_mask:0xf
  v_add_f32_dpp v208, v208, v208 row_ror:2 row_mask:0xf bank_mask:0xf
  v_add_f32_dpp v209, v209, v209 row_ror:2 row_mask:0xf bank_mask:0xf
  v_add_f32_dpp v210, v210, v210 row_ror:2 row_mask:0xf bank_mask:0xf
  v_add_f32_dpp v211, v211, v211 row_ror:2 row_mask:0xf bank_mask:0xf
  v_add_f32_dpp v208, v208, v208 row_ror:1 row_mask:0xf bank_mask:0xf
  v_add_f32_dpp v209, v209, v209 row_ror:1 row_mask:0xf bank_mask:0xf
  v_add_f32_dpp v210, v210, v210 row_ror:1 row_mask:0xf bank_mask:0xf
  v_add_f32_dpp v211, v211, v211 row_ror:1 row_mask:0xf bank_mask:0xf
  v_cvt_pk_bf16_f32 v24, v208, v209
  v_cvt_pk_bf16_f32 v25, v210, v211
  v_lshlrev_b32 v208, 16, v24
  v_and_b32 v209, 0xffff0000, v24
  v_lshlrev_b32 v210, 16, v25
  v_and_b32 v211, 0xffff0000, v25
  v_mul_f32 v208, s71, v208
  v_mul_f32 v209, s71, v209
  v_mul_f32 v210, s71, v210
  v_mul_f32 v211, s71, v211
  v_cvt_pk_bf16_f32 v24, v208, v209
  v_cvt_pk_bf16_f32 v25, v210, v211
  v_lshlrev_b32 v208, 16, v24
  v_and_b32 v209, 0xffff0000, v24
  v_lshlrev_b32 v210, 16, v25
  v_and_b32 v211, 0xffff0000, v25
  v_max3_f32 v13, v13, v208, v209
  v_max3_f32 v13, v13, v210, v211
  s_waitcnt vmcnt(4)
  buffer_load_dwordx4 v[84:87], v1, s[44:47], s64 offen nt
  s_add_u32 s64, s64, 4096
  buffer_load_dwordx4 v[88:91], v1, s[44:47], s64 offen nt
  s_add_u32 s64, s64, 4096
  buffer_load_dwordx4 v[92:95], v1, s[44:47], s64 offen nt
  s_add_u32 s64, s64, 4096
  buffer_load_dwordx4 v[96:99], v1, s[44:47], s64 offen nt
  s_add_u32 s64, s64, 4096
  v_dot2_f32_bf16 v212, v52, v4, 0
  v_dot2_f32_bf16 v213, v56, v4, 0
  v_dot2_f32_bf16 v214, v60, v4, 0
  v_dot2_f32_bf16 v215, v64, v4, 0
  v_dot2_f32_bf16 v212, v53, v5, v212
  v_dot2_f32_bf16 v213, v57, v5, v213
  v_dot2_f32_bf16 v214, v61, v5, v214
  v_dot2_f32_bf16 v215, v65, v5, v215
  v_dot2_f32_bf16 v212, v54, v6, v212
  v_dot2_f32_bf16 v213, v58, v6, v213
  v_dot2_f32_bf16 v214, v62, v6, v214
  v_dot2_f32_bf16 v215, v66, v6, v215
  v_dot2_f32_bf16 v212, v55, v7, v212
  v_dot2_f32_bf16 v213, v59, v7, v213
  v_dot2_f32_bf16 v214, v63, v7, v214
  v_dot2_f32_bf16 v215, v67, v7, v215
  v_add_f32_dpp v212, v212, v212 row_ror:8 row_mask:0xf bank_mask:0xf
  v_add_f32_dpp v213, v213, v213 row_ror:8 row_mask:0xf bank_mask:0xf
  v_add_f32_dpp v214, v214, v214 row_ror:8 row_mask:0xf bank_mask:0xf
  v_add_f32_dpp v215, v215, v215 row_ror:8 row_mask:0xf bank_mask:0xf
  v_add_f32_dpp v212, v212, v212 row_ror:4 row_mask:0xf bank_mask:0xf
  v_add_f32_dpp v213, v213, v213 row_ror:4 row_mask:0xf bank_mask:0xf
  v_add_f32_dpp v214, v214, v214 row_ror:4 row_mask:0xf bank_mask:0xf
  v_add_f32_dpp v215, v215, v215 row_ror:4 row_mask:0xf bank_mask:0xf
  v_add_f32_dpp v212, v212, v212 row_ror:2 row_mask:0xf bank_mask:0xf
  v_add_f32_dpp v213, v213, v213 row_ror:2 row_mask:0xf bank_mask:0xf
  v_add_f32_dpp v214, v214, v214 row_ror:2 row_mask:0xf bank_mask:0xf
  v_add_f32_dpp v215, v215, v215 row_ror:2 row_mask:0xf bank_mask:0xf
  v_add_f32_dpp v212, v212, v212 row_ror:1 row_mask:0xf bank_mask:0xf
  v_add_f32_dpp v213, v213, v213 row_ror:1 row_mask:0xf bank_mask:0xf
  v_add_f32_dpp v214, v214, v214 row_ror:1 row_mask:0xf bank_mask:0xf
  v_add_f32_dpp v215, v215, v215 row_ror:1 row_mask:0xf bank_mask:0xf
  v_cvt_pk_bf16_f32 v24, v212, v213
  v_cvt_pk_bf16_f32 v25, v214, v215
  v_lshlrev_b32 v212, 16, v24
  v_and_b32 v213, 0xffff0000, v24
  v_lshlrev_b32 v214, 16, v25
  v_and_b32 v215, 0xffff0000, v25
  v_mul_f32 v212, s71, v212
  v_mul_f32 v213, s71, v213
  v_mul_f32 v214, s71, v214
  v_mul_f32 v215, s71, v215
  v_cvt_pk_bf16_f32 v24, v212, v213
  v_cvt_pk_bf16_f32 v25, v214, v215
  v_lshlrev_b32 v212, 16, v24
  v_and_b32 v213, 0xffff0000, v24
  v_lshlrev_b32 v214, 16, v25
  v_and_b32 v215, 0xffff0000, v25
  v_max3_f32 v13, v13, v212, v213
  v_max3_f32 v13, v13, v214, v215
  s_waitcnt vmcnt(4)
  buffer_load_dwordx4 v[100:103], v1, s[44:47], s64 offen nt
  s_add_u32 s64, s64, 4096
  buffer_load_dwordx4 v[104:107], v1, s[44:47], s64 offen nt
  s_add_u32 s64, s64, 4096
  buffer_load_dwordx4 v[108:111], v1, s[44:47], s64 offen nt
  s_add_u32 s64, s64, 4096
  buffer_load_dwordx4 v[112:115], v1, s[44:47], s64 offen nt
  s_add_u32 s64, s64, 4096
  v_dot2_f32_bf16 v216, v68, v4, 0
  v_dot2_f32_bf16 v217, v72, v4, 0
  v_dot2_f32_bf16 v218, v76, v4, 0
  v_dot2_f32_bf16 v219, v80, v4, 0
  v_dot2_f32_bf16 v216, v69, v5, v216
  v_dot2_f32_bf16 v217, v73, v5, v217
  v_dot2_f32_bf16 v218, v77, v5, v218
  v_dot2_f32_bf16 v219, v81, v5, v219
  v_dot2_f32_bf16 v216, v70, v6, v216
  v_dot2_f32_bf16 v217, v74, v6, v217
  v_dot2_f32_bf16 v218, v78, v6, v218
  v_dot2_f32_bf16 v219, v82, v6, v219
  v_dot2_f32_bf16 v216, v71, v7, v216
  v_dot2_f32_bf16 v217, v75, v7, v217
  v_dot2_f32_bf16 v218, v79, v7, v218
  v_dot2_f32_bf16 v219, v83, v7, v219
  v_add_f32_dpp v216, v216, v216 row_ror:8 row_mask:0xf bank_mask:0xf
  v_add_f32_dpp v217, v217, v217 row_ror:8 row_mask:0xf bank_mask:0xf
  v_add_f32_dpp v218, v218, v218 row_ror:8 row_mask:0xf bank_mask:0xf
  v_add_f32_dpp v219, v219, v219 row_ror:8 row_mask:0xf bank_mask:0xf
  v_add_f32_dpp v216, v216, v216 row_ror:4 row_mask:0xf bank_mask:0xf
  v_add_f32_dpp v217, v217, v217 row_ror:4 row_mask:0xf bank_mask:0xf
  v_add_f32_dpp v218, v218, v218 row_ror:4 row_mask:0xf bank_mask:0xf
  v_add_f32_dpp v219, v219, v219 row_ror:4 row_mask:0xf bank_mask:0xf
  v_add_f32_dpp v216, v216, v216 row_ror:2 row_mask:0xf bank_mask:0xf
  v_add_f32_dpp v217, v217, v217 row_ror:2 row_mask:0xf bank_mask:0xf
  v_add_f32_dpp v218, v218, v218 row_ror:2 row_mask:0xf bank_mask:0xf
  v_add_f32_dpp v219, v219, v219 row_ror:2 row_mask:0xf bank_mask:0xf
  v_add_f32_dpp v216, v216, v216 row_ror:1 row_mask:0xf bank_mask:0xf
  v_add_f32_dpp v217, v217, v217 row_ror:1 row_mask:0xf bank_mask:0xf
  v_add_f32_dpp v218, v218, v218 row_ror:1 row_mask:0xf bank_mask:0xf
  v_add_f32_dpp v219, v219, v219 row_ror:1 row_mask:0xf bank_mask:0xf
  v_cvt_pk_bf16_f32 v24, v216, v217
  v_cvt_pk_bf16_f32 v25, v218, v219
  v_lshlrev_b32 v216, 16, v24
  v_and_b32 v217, 0xffff0000, v24
  v_lshlrev_b32 v218, 16, v25
  v_and_b32 v219, 0xffff0000, v25
  v_mul_f32 v216, s71, v216
  v_mul_f32 v217, s71, v217
  v_mul_f32 v218, s71, v218
  v_mul_f32 v219, s71, v219
  v_cvt_pk_bf16_f32 v24, v216, v217
  v_cvt_pk_bf16_f32 v25, v218, v219
  v_lshlrev_b32 v216, 16, v24
  v_and_b32 v217, 0xffff0000, v24
  v_lshlrev_b32 v218, 16, v25
  v_and_b32 v219, 0xffff0000, v25
  v_max3_f32 v13, v13, v216, v217
  v_max3_f32 v13, v13, v218, v219
  v_mov_b32 v30, 3
  s_mov_b64 exec, 1
  ds_write_b32 v20, v30
  s_mov_b64 exec, -1
  s_waitcnt vmcnt(4)
  buffer_load_dwordx4 v[52:55], v1, s[44:47], s64 offen nt
  s_add_u32 s64, s64, 4096
  buffer_load_dwordx4 v[56:59], v1, s[44:47], s64 offen nt
  s_add_u32 s64, s64, 4096
  buffer_load_dwordx4 v[60:63], v1, s[44:47], s64 offen nt
  s_add_u32 s64, s64, 4096
  buffer_load_dwordx4 v[64:67], v1, s[44:47], s64 offen nt
  s_add_u32 s64, s64, 4096
  v_dot2_f32_bf16 v220, v84, v4, 0
  v_dot2_f32_bf16 v221, v88, v4, 0
  v_dot2_f32_bf16 v222, v92, v4, 0
  v_dot2_f32_bf16 v223, v96, v4, 0
  v_dot2_f32_bf16 v220, v85, v5, v220
  v_dot2_f32_bf16 v221, v89, v5, v221
  v_dot2_f32_bf16 v222, v93, v5, v222
  v_dot2_f32_bf16 v223, v97, v5, v223
  v_dot2_f32_bf16 v220, v86, v6, v220
  v_dot2_f32_bf16 v221, v90, v6, v221
  v_dot2_f32_bf16 v222, v94, v6, v222
  v_dot2_f32_bf16 v223, v98, v6, v223
  v_dot2_f32_bf16 v220, v87, v7, v220
  v_dot2_f32_bf16 v221, v91, v7, v221
  v_dot2_f32_bf16 v222, v95, v7, v222
  v_dot2_f32_bf16 v223, v99, v7, v223
  v_add_f32_dpp v220, v220, v220 row_ror:8 row_mask:0xf bank_mask:0xf
  v_add_f32_dpp v221, v221, v221 row_ror:8 row_mask:0xf bank_mask:0xf
  v_add_f32_dpp v222, v222, v222 row_ror:8 row_mask:0xf bank_mask:0xf
  v_add_f32_dpp v223, v223, v223 row_ror:8 row_mask:0xf bank_mask:0xf
  v_add_f32_dpp v220, v220, v220 row_ror:4 row_mask:0xf bank_mask:0xf
  v_add_f32_dpp v221, v221, v221 row_ror:4 row_mask:0xf bank_mask:0xf
  v_add_f32_dpp v222, v222, v222 row_ror:4 row_mask:0xf bank_mask:0xf
  v_add_f32_dpp v223, v223, v223 row_ror:4 row_mask:0xf bank_mask:0xf
  v_add_f32_dpp v220, v220, v220 row_ror:2 row_mask:0xf bank_mask:0xf
  v_add_f32_dpp v221, v221, v221 row_ror:2 row_mask:0xf bank_mask:0xf
  v_add_f32_dpp v222, v222, v222 row_ror:2 row_mask:0xf bank_mask:0xf
  v_add_f32_dpp v223, v223, v223 row_ror:2 row_mask:0xf bank_mask:0xf
  v_add_f32_dpp v220, v220, v220 row_ror:1 row_mask:0xf bank_mask:0xf
  v_add_f32_dpp v221, v221, v221 row_ror:1 row_mask:0xf bank_mask:0xf
  v_add_f32_dpp v222, v222, v222 row_ror:1 row_mask:0xf bank_mask:0xf
  v_add_f32_dpp v223, v223, v223 row_ror:1 row_mask:0xf bank_mask:0xf
  v_cvt_pk_bf16_f32 v24, v220, v221
  v_cvt_pk_bf16_f32 v25, v222, v223
  v_lshlrev_b32 v220, 16, v24
  v_and_b32 v221, 0xffff0000, v24
  v_lshlrev_b32 v222, 16, v25
  v_and_b32 v223, 0xffff0000, v25
  v_mul_f32 v220, s71, v220
  v_mul_f32 v221, s71, v221
  v_mul_f32 v222, s71, v222
  v_mul_f32 v223, s71, v223
  v_cvt_pk_bf16_f32 v24, v220, v221
  v_cvt_pk_bf16_f32 v25, v222, v223
  v_lshlrev_b32 v220, 16, v24
  v_and_b32 v221, 0xffff0000, v24
  v_lshlrev_b32 v222, 16, v25
  v_and_b32 v223, 0xffff0000, v25
  v_max3_f32 v13, v13, v220, v221
  v_max3_f32 v13, v13, v222, v223
  s_waitcnt vmcnt(4)
  buffer_load_dwordx4 v[68:71], v1, s[44:47], s64 offen nt
  s_add_u32 s64, s64, 4096
  buffer_load_dwordx4 v[72:75], v1, s[44:47], s64 offen nt
  s_add_u32 s64, s64, 4096
  buffer_load_dwordx4 v[76:79], v1, s[44:47], s64 offen nt
  s_add_u32 s64, s64, 4096
  buffer_load_dwordx4 v[80:83], v1, s[44:47], s64 offen nt
  s_add_u32 s64, s64, 4096
  v_dot2_f32_bf16 v224, v100, v4, 0
  v_dot2_f32_bf16 v225, v104, v4, 0
  v_dot2_f32_bf16 v226, v108, v4, 0
  v_dot2_f32_bf16 v227, v112, v4, 0
  v_dot2_f32_bf16 v224, v101, v5, v224
  v_dot2_f32_bf16 v225, v105, v5, v225
  v_dot2_f32_bf16 v226, v109, v5, v226
  v_dot2_f32_bf16 v227, v113, v5, v227
  v_dot2_f32_bf16 v224, v102, v6, v224
  v_dot2_f32_bf16 v225, v106, v6, v225
  v_dot2_f32_bf16 v226, v110, v6, v226
  v_dot2_f32_bf16 v227, v114, v6, v227
  v_dot2_f32_bf16 v224, v103, v7, v224
  v_dot2_f32_bf16 v225, v107, v7, v225
  v_dot2_f32_bf16 v226, v111, v7, v226
  v_dot2_f32_bf16 v227, v115, v7, v227
  v_add_f32_dpp v224, v224, v224 row_ror:8 row_mask:0xf bank_mask:0xf
  v_add_f32_dpp v225, v225, v225 row_ror:8 row_mask:0xf bank_mask:0xf
  v_add_f32_dpp v226, v226, v226 row_ror:8 row_mask:0xf bank_mask:0xf
  v_add_f32_dpp v227, v227, v227 row_ror:8 row_mask:0xf bank_mask:0xf
  v_add_f32_dpp v224, v224, v224 row_ror:4 row_mask:0xf bank_mask:0xf
  v_add_f32_dpp v225, v225, v225 row_ror:4 row_mask:0xf bank_mask:0xf
  v_add_f32_dpp v226, v226, v226 row_ror:4 row_mask:0xf bank_mask:0xf
  v_add_f32_dpp v227, v227, v227 row_ror:4 row_mask:0xf bank_mask:0xf
  v_add_f32_dpp v224, v224, v224 row_ror:2 row_mask:0xf bank_mask:0xf
  v_add_f32_dpp v225, v225, v225 row_ror:2 row_mask:0xf bank_mask:0xf
  v_add_f32_dpp v226, v226, v226 row_ror:2 row_mask:0xf bank_mask:0xf
  v_add_f32_dpp v227, v227, v227 row_ror:2 row_mask:0xf bank_mask:0xf
  v_add_f32_dpp v224, v224, v224 row_ror:1 row_mask:0xf bank_mask:0xf
  v_add_f32_dpp v225, v225, v225 row_ror:1 row_mask:0xf bank_mask:0xf
  v_add_f32_dpp v226, v226, v226 row_ror:1 row_mask:0xf bank_mask:0xf
  v_add_f32_dpp v227, v227, v227 row_ror:1 row_mask:0xf bank_mask:0xf
  v_cvt_pk_bf16_f32 v24, v224, v225
  v_cvt_pk_bf16_f32 v25, v226, v227
  v_lshlrev_b32 v224, 16, v24
  v_and_b32 v225, 0xffff0000, v24
  v_lshlrev_b32 v226, 16, v25
  v_and_b32 v227, 0xffff0000, v25
  v_mul_f32 v224, s71, v224
  v_mul_f32 v225, s71, v225
  v_mul_f32 v226, s71, v226
  v_mul_f32 v227, s71, v227
  v_cvt_pk_bf16_f32 v24, v224, v225
  v_cvt_pk_bf16_f32 v25, v226, v227
  v_lshlrev_b32 v224, 16, v24
  v_and_b32 v225, 0xffff0000, v24
  v_lshlrev_b32 v226, 16, v25
  v_and_b32 v227, 0xffff0000, v25
  v_max3_f32 v13, v13, v224, v225
  v_max3_f32 v13, v13, v226, v227
  s_waitcnt vmcnt(4)
  buffer_load_dwordx4 v[84:87], v1, s[44:47], s64 offen nt
  s_add_u32 s64, s64, 4096
  buffer_load_dwordx4 v[88:91], v1, s[44:47], s64 offen nt
  s_add_u32 s64, s64, 4096
  buffer_load_dwordx4 v[92:95], v1, s[44:47], s64 offen nt
  s_add_u32 s64, s64, 4096
  buffer_load_dwordx4 v[96:99], v1, s[44:47], s64 offen nt
  s_add_u32 s64, s64, 4096
  v_dot2_f32_bf16 v228, v52, v4, 0
  v_dot2_f32_bf16 v229, v56, v4, 0
  v_dot2_f32_bf16 v230, v60, v4, 0
  v_dot2_f32_bf16 v231, v64, v4, 0
  v_dot2_f32_bf16 v228, v53, v5, v228
  v_dot2_f32_bf16 v229, v57, v5, v229
  v_dot2_f32_bf16 v230, v61, v5, v230
  v_dot2_f32_bf16 v231, v65, v5, v231
  v_dot2_f32_bf16 v228, v54, v6, v228
  v_dot2_f32_bf16 v229, v58, v6, v229
  v_dot2_f32_bf16 v230, v62, v6, v230
  v_dot2_f32_bf16 v231, v66, v6, v231
  v_dot2_f32_bf16 v228, v55, v7, v228
  v_dot2_f32_bf16 v229, v59, v7, v229
  v_dot2_f32_bf16 v230, v63, v7, v230
  v_dot2_f32_bf16 v231, v67, v7, v231
  v_add_f32_dpp v228, v228, v228 row_ror:8 row_mask:0xf bank_mask:0xf
  v_add_f32_dpp v229, v229, v229 row_ror:8 row_mask:0xf bank_mask:0xf
  v_add_f32_dpp v230, v230, v230 row_ror:8 row_mask:0xf bank_mask:0xf
  v_add_f32_dpp v231, v231, v231 row_ror:8 row_mask:0xf bank_mask:0xf
  v_add_f32_dpp v228, v228, v228 row_ror:4 row_mask:0xf bank_mask:0xf
  v_add_f32_dpp v229, v229, v229 row_ror:4 row_mask:0xf bank_mask:0xf
  v_add_f32_dpp v230, v230, v230 row_ror:4 row_mask:0xf bank_mask:0xf
  v_add_f32_dpp v231, v231, v231 row_ror:4 row_mask:0xf bank_mask:0xf
  v_add_f32_dpp v228, v228, v228 row_ror:2 row_mask:0xf bank_mask:0xf
  v_add_f32_dpp v229, v229, v229 row_ror:2 row_mask:0xf bank_mask:0xf
  v_add_f32_dpp v230, v230, v230 row_ror:2 row_mask:0xf bank_mask:0xf
  v_add_f32_dpp v231, v231, v231 row_ror:2 row_mask:0xf bank_mask:0xf
  v_add_f32_dpp v228, v228, v228 row_ror:1 row_mask:0xf bank_mask:0xf
  v_add_f32_dpp v229, v229, v229 row_ror:1 row_mask:0xf bank_mask:0xf
  v_add_f32_dpp v230, v230, v230 row_ror:1 row_mask:0xf bank_mask:0xf
  v_add_f32_dpp v231, v231, v231 row_ror:1 row_mask:0xf bank_mask:0xf
  v_cvt_pk_bf16_f32 v24, v228, v229
  v_cvt_pk_bf16_f32 v25, v230, v231
  v_lshlrev_b32 v228, 16, v24
  v_and_b32 v229, 0xffff0000, v24
  v_lshlrev_b32 v230, 16, v25
  v_and_b32 v231, 0xffff0000, v25
  v_mul_f32 v228, s71, v228
  v_mul_f32 v229, s71, v229
  v_mul_f32 v230, s71, v230
  v_mul_f32 v231, s71, v231
  v_cvt_pk_bf16_f32 v24, v228, v229
  v_cvt_pk_bf16_f32 v25, v230, v231
  v_lshlrev_b32 v228, 16, v24
  v_and_b32 v229, 0xffff0000, v24
  v_lshlrev_b32 v230, 16, v25
  v_and_b32 v231, 0xffff0000, v25
  v_max3_f32 v13, v13, v228, v229
  v_max3_f32 v13, v13, v230, v231
  s_waitcnt vmcnt(4)
  buffer_load_dwordx4 v[100:103], v1, s[44:47], s64 offen nt
  s_add_u32 s64, s64, 4096
  buffer_load_dwordx4 v[104:107], v1, s[44:47], s64 offen nt
  s_add_u32 s64, s64, 4096
  buffer_load_dwordx4 v[108:111], v1, s[44:47], s64 offen nt
  s_add_u32 s64, s64, 4096
  buffer_load_dwordx4 v[112:115], v1, s[44:47], s64 offen nt
  v_dot2_f32_bf16 v232, v68, v4, 0
  v_dot2_f32_bf16 v233, v72, v4, 0
  v_dot2_f32_bf16 v234, v76, v4, 0
  v_dot2_f32_bf16 v235, v80, v4, 0
  v_dot2_f32_bf16 v232, v69, v5, v232
  v_dot2_f32_bf16 v233, v73, v5, v233
  v_dot2_f32_bf16 v234, v77, v5, v234
  v_dot2_f32_bf16 v235, v81, v5, v235
  v_dot2_f32_bf16 v232, v70, v6, v232
  v_dot2_f32_bf16 v233, v74, v6, v233
  v_dot2_f32_bf16 v234, v78, v6, v234
  v_dot2_f32_bf16 v235, v82, v6, v235
  v_dot2_f32_bf16 v232, v71, v7, v232
  v_dot2_f32_bf16 v233, v75, v7, v233
  v_dot2_f32_bf16 v234, v79, v7, v234
  v_dot2_f32_bf16 v235, v83, v7, v235
  v_add_f32_dpp v232, v232, v232 row_ror:8 row_mask:0xf bank_mask:0xf
  v_add_f32_dpp v233, v233, v233 row_ror:8 row_mask:0xf bank_mask:0xf
  v_add_f32_dpp v234, v234, v234 row_ror:8 row_mask:0xf bank_mask:0xf
  v_add_f32_dpp v235, v235, v235 row_ror:8 row_mask:0xf bank_mask:0xf
  v_add_f32_dpp v232, v232, v232 row_ror:4 row_mask:0xf bank_mask:0xf
  v_add_f32_dpp v233, v233, v233 row_ror:4 row_mask:0xf bank_mask:0xf
  v_add_f32_dpp v234, v234, v234 row_ror:4 row_mask:0xf bank_mask:0xf
  v_add_f32_dpp v235, v235, v235 row_ror:4 row_mask:0xf bank_mask:0xf
  v_add_f32_dpp v232, v232, v232 row_ror:2 row_mask:0xf bank_mask:0xf
  v_add_f32_dpp v233, v233, v233 row_ror:2 row_mask:0xf bank_mask:0xf
  v_add_f32_dpp v234, v234, v234 row_ror:2 row_mask:0xf bank_mask:0xf
  v_add_f32_dpp v235, v235, v235 row_ror:2 row_mask:0xf bank_mask:0xf
  v_add_f32_dpp v232, v232, v232 row_ror:1 row_mask:0xf bank_mask:0xf
  v_add_f32_dpp v233, v233, v233 row_ror:1 row_mask:0xf bank_mask:0xf
  v_add_f32_dpp v234, v234, v234 row_ror:1 row_mask:0xf bank_mask:0xf
  v_add_f32_dpp v235, v235, v235 row_ror:1 row_mask:0xf bank_mask:0xf
  v_cvt_pk_bf16_f32 v24, v232, v233
  v_cvt_pk_bf16_f32 v25, v234, v235
  v_lshlrev_b32 v232, 16, v24
  v_and_b32 v233, 0xffff0000, v24
  v_lshlrev_b32 v234, 16, v25
  v_and_b32 v235, 0xffff0000, v25
  v_mul_f32 v232, s71, v232
  v_mul_f32 v233, s71, v233
  v_mul_f32 v234, s71, v234
  v_mul_f32 v235, s71, v235
  v_cvt_pk_bf16_f32 v24, v232, v233
  v_cvt_pk_bf16_f32 v25, v234, v235
  v_lshlrev_b32 v232, 16, v24
  v_and_b32 v233, 0xffff0000, v24
  v_lshlrev_b32 v234, 16, v25
  v_and_b32 v235, 0xffff0000, v25
  v_max3_f32 v13, v13, v232, v233
  v_max3_f32 v13, v13, v234, v235
  s_waitcnt vmcnt(4)
  buffer_load_dwordx4 v[52:55], v1, s[48:51], s65 offen nt
  s_add_u32 s65, s65, 4096
  buffer_load_dwordx4 v[56:59], v1, s[48:51], s65 offen nt
  s_add_u32 s65, s65, 4096
  buffer_load_dwordx4 v[60:63], v1, s[48:51], s65 offen nt
  s_add_u32 s65, s65, 4096
  buffer_load_dwordx4 v[64:67], v1, s[48:51], s65 offen nt
  s_add_u32 s65, s65, 4096
  v_dot2_f32_bf16 v236, v84, v4, 0
  v_dot2_f32_bf16 v237, v88, v4, 0
  v_dot2_f32_bf16 v238, v92, v4, 0
  v_dot2_f32_bf16 v239, v96, v4, 0
  v_dot2_f32_bf16 v236, v85, v5, v236
  v_dot2_f32_bf16 v237, v89, v5, v237
  v_dot2_f32_bf16 v238, v93, v5, v238
  v_dot2_f32_bf16 v239, v97, v5, v239
  v_dot2_f32_bf16 v236, v86, v6, v236
  v_dot2_f32_bf16 v237, v90, v6, v237
  v_dot2_f32_bf16 v238, v94, v6, v238
  v_dot2_f32_bf16 v239, v98, v6, v239
  v_dot2_f32_bf16 v236, v87, v7, v236
  v_dot2_f32_bf16 v237, v91, v7, v237
  v_dot2_f32_bf16 v238, v95, v7, v238
  v_dot2_f32_bf16 v239, v99, v7, v239
  v_add_f32_dpp v236, v236, v236 row_ror:8 row_mask:0xf bank_mask:0xf
  v_add_f32_dpp v237, v237, v237 row_ror:8 row_mask:0xf bank_mask:0xf
  v_add_f32_dpp v238, v238, v238 row_ror:8 row_mask:0xf bank_mask:0xf
  v_add_f32_dpp v239, v239, v239 row_ror:8 row_mask:0xf bank_mask:0xf
  v_add_f32_dpp v236, v236, v236 row_ror:4 row_mask:0xf bank_mask:0xf
  v_add_f32_dpp v237, v237, v237 row_ror:4 row_mask:0xf bank_mask:0xf
  v_add_f32_dpp v238, v238, v238 row_ror:4 row_mask:0xf bank_mask:0xf
  v_add_f32_dpp v239, v239, v239 row_ror:4 row_mask:0xf bank_mask:0xf
  v_add_f32_dpp v236, v236, v236 row_ror:2 row_mask:0xf bank_mask:0xf
  v_add_f32_dpp v237, v237, v237 row_ror:2 row_mask:0xf bank_mask:0xf
  v_add_f32_dpp v238, v238, v238 row_ror:2 row_mask:0xf bank_mask:0xf
  v_add_f32_dpp v239, v239, v239 row_ror:2 row_mask:0xf bank_mask:0xf
  v_add_f32_dpp v236, v236, v236 row_ror:1 row_mask:0xf bank_mask:0xf
  v_add_f32_dpp v237, v237, v237 row_ror:1 row_mask:0xf bank_mask:0xf
  v_add_f32_dpp v238, v238, v238 row_ror:1 row_mask:0xf bank_mask:0xf
  v_add_f32_dpp v239, v239, v239 row_ror:1 row_mask:0xf bank_mask:0xf
  v_cvt_pk_bf16_f32 v24, v236, v237
  v_cvt_pk_bf16_f32 v25, v238, v239
  v_lshlrev_b32 v236, 16, v24
  v_and_b32 v237, 0xffff0000, v24
  v_lshlrev_b32 v238, 16, v25
  v_and_b32 v239, 0xffff0000, v25
  v_mul_f32 v236, s71, v236
  v_mul_f32 v237, s71, v237
  v_mul_f32 v238, s71, v238
  v_mul_f32 v239, s71, v239
  v_cvt_pk_bf16_f32 v24, v236, v237
  v_cvt_pk_bf16_f32 v25, v238, v239
  v_lshlrev_b32 v236, 16, v24
  v_and_b32 v237, 0xffff0000, v24
  v_lshlrev_b32 v238, 16, v25
  v_and_b32 v239, 0xffff0000, v25
  v_max3_f32 v13, v13, v236, v237
  v_max3_f32 v13, v13, v238, v239
  s_waitcnt vmcnt(4)
  buffer_load_dwordx4 v[68:71], v1, s[48:51], s65 offen nt
  s_add_u32 s65, s65, 4096
  buffer_load_dwordx4 v[72:75], v1, s[48:51], s65 offen nt
  s_add_u32 s65, s65, 4096
  buffer_load_dwordx4 v[76:79], v1, s[48:51], s65 offen nt
  s_add_u32 s65, s65, 4096
  buffer_load_dwordx4 v[80:83], v1, s[48:51], s65 offen nt
  s_add_u32 s65, s65, 4096
  v_dot2_f32_bf16 v240, v100, v4, 0
  v_dot2_f32_bf16 v241, v104, v4, 0
  v_dot2_f32_bf16 v242, v108, v4, 0
  v_dot2_f32_bf16 v243, v112, v4, 0
  v_dot2_f32_bf16 v240, v101, v5, v240
  v_dot2_f32_bf16 v241, v105, v5, v241
  v_dot2_f32_bf16 v242, v109, v5, v242
  v_dot2_f32_bf16 v243, v113, v5, v243
  v_dot2_f32_bf16 v240, v102, v6, v240
  v_dot2_f32_bf16 v241, v106, v6, v241
  v_dot2_f32_bf16 v242, v110, v6, v242
  v_dot2_f32_bf16 v243, v114, v6, v243
  v_dot2_f32_bf16 v240, v103, v7, v240
  v_dot2_f32_bf16 v241, v107, v7, v241
  v_dot2_f32_bf16 v242, v111, v7, v242
  v_dot2_f32_bf16 v243, v115, v7, v243
  v_add_f32_dpp v240, v240, v240 row_ror:8 row_mask:0xf bank_mask:0xf
  v_add_f32_dpp v241, v241, v241 row_ror:8 row_mask:0xf bank_mask:0xf
  v_add_f32_dpp v242, v242, v242 row_ror:8 row_mask:0xf bank_mask:0xf
  v_add_f32_dpp v243, v243, v243 row_ror:8 row_mask:0xf bank_mask:0xf
  v_add_f32_dpp v240, v240, v240 row_ror:4 row_mask:0xf bank_mask:0xf
  v_add_f32_dpp v241, v241, v241 row_ror:4 row_mask:0xf bank_mask:0xf
  v_add_f32_dpp v242, v242, v242 row_ror:4 row_mask:0xf bank_mask:0xf
  v_add_f32_dpp v243, v243, v243 row_ror:4 row_mask:0xf bank_mask:0xf
  v_add_f32_dpp v240, v240, v240 row_ror:2 row_mask:0xf bank_mask:0xf
  v_add_f32_dpp v241, v241, v241 row_ror:2 row_mask:0xf bank_mask:0xf
  v_add_f32_dpp v242, v242, v242 row_ror:2 row_mask:0xf bank_mask:0xf
  v_add_f32_dpp v243, v243, v243 row_ror:2 row_mask:0xf bank_mask:0xf
  v_add_f32_dpp v240, v240, v240 row_ror:1 row_mask:0xf bank_mask:0xf
  v_add_f32_dpp v241, v241, v241 row_ror:1 row_mask:0xf bank_mask:0xf
  v_add_f32_dpp v242, v242, v242 row_ror:1 row_mask:0xf bank_mask:0xf
  v_add_f32_dpp v243, v243, v243 row_ror:1 row_mask:0xf bank_mask:0xf
  v_cvt_pk_bf16_f32 v24, v240, v241
  v_cvt_pk_bf16_f32 v25, v242, v243
  v_lshlrev_b32 v240, 16, v24
  v_and_b32 v241, 0xffff0000, v24
  v_lshlrev_b32 v242, 16, v25
  v_and_b32 v243, 0xffff0000, v25
  v_mul_f32 v240, s71, v240
  v_mul_f32 v241, s71, v241
  v_mul_f32 v242, s71, v242
  v_mul_f32 v243, s71, v243
  v_cvt_pk_bf16_f32 v24, v240, v241
  v_cvt_pk_bf16_f32 v25, v242, v243
  v_lshlrev_b32 v240, 16, v24
  v_and_b32 v241, 0xffff0000, v24
  v_lshlrev_b32 v242, 16, v25
  v_and_b32 v243, 0xffff0000, v25
  v_max3_f32 v13, v13, v240, v241
  v_max3_f32 v13, v13, v242, v243
  v_mov_b32 v26, v13
  s_nop 1
  v_permlane16_swap_b32 v13, v26
  s_nop 0
  v_max_f32 v13, v13, v26
  v_mov_b32 v26, v13
  s_nop 1
  v_permlane32_swap_b32 v13, v26
  s_nop 0
  v_max_f32 v13, v13, v26
  v_mul_f32 v14, s70, v13
  v_sub_f32 v14, 0, v14
  v_mov_b32 v15, 0
  v_mov_b32 v16, 0
  buffer_load_dwordx4 v[84:87], v1, s[48:51], s65 offen nt
  s_add_u32 s65, s65, 4096
  v_fma_f32 v180, v180, s70, v14
  v_fma_f32 v181, v181, s70, v14
  v_fma_f32 v182, v182, s70, v14
  v_fma_f32 v183, v183, s70, v14
  v_exp_f32 v180, v180
  v_exp_f32 v181, v181
  v_exp_f32 v182, v182
  v_exp_f32 v183, v183
  v_add_f32 v15, v15, v180
  v_add_f32 v16, v16, v181
  v_add_f32 v15, v15, v182
  v_add_f32 v16, v16, v183
  v_cvt_pk_bf16_f32 v180, v180, v180
  v_cvt_pk_bf16_f32 v181, v181, v181
  v_cvt_pk_bf16_f32 v182, v182, v182
  v_cvt_pk_bf16_f32 v183, v183, v183
  v_fma_f32 v184, v184, s70, v14
  v_fma_f32 v185, v185, s70, v14
  v_fma_f32 v186, v186, s70, v14
  v_fma_f32 v187, v187, s70, v14
  v_exp_f32 v184, v184
  v_exp_f32 v185, v185
  v_exp_f32 v186, v186
  v_exp_f32 v187, v187
  v_add_f32 v15, v15, v184
  v_add_f32 v16, v16, v185
  v_add_f32 v15, v15, v186
  v_add_f32 v16, v16, v187
  v_cvt_pk_bf16_f32 v184, v184, v184
  v_cvt_pk_bf16_f32 v185, v185, v185
  v_cvt_pk_bf16_f32 v186, v186, v186
  v_cvt_pk_bf16_f32 v187, v187, v187
  buffer_load_dwordx4 v[88:91], v1, s[48:51], s65 offen nt
  s_add_u32 s65, s65, 4096
  v_fma_f32 v188, v188, s70, v14
  v_fma_f32 v189, v189, s70, v14
  v_fma_f32 v190, v190, s70, v14
  v_fma_f32 v191, v191, s70, v14
  v_exp_f32 v188, v188
  v_exp_f32 v189, v189
  v_exp_f32 v190, v190
  v_exp_f32 v191, v191
  v_add_f32 v15, v15, v188
  v_add_f32 v16, v16, v189
  v_add_f32 v15, v15, v190
  v_add_f32 v16, v16, v191
  v_cvt_pk_bf16_f32 v188, v188, v188
  v_cvt_pk_bf16_f32 v189, v189, v189
  v_cvt_pk_bf16_f32 v190, v190, v190
  v_cvt_pk_bf16_f32 v191, v191, v191
  v_fma_f32 v192, v192, s70, v14
  v_fma_f32 v193, v193, s70, v14
  v_fma_f32 v194, v194, s70, v14
  v_fma_f32 v195, v195, s70, v14
  v_exp_f32 v192, v192
  v_exp_f32 v193, v193
  v_exp_f32 v194, v194
  v_exp_f32 v195, v195
  v_add_f32 v15, v15, v192
  v_add_f32 v16, v16, v193
  v_add_f32 v15, v15, v194
  v_add_f32 v16, v16, v195
  v_cvt_pk_bf16_f32 v192, v192, v192
  v_cvt_pk_bf16_f32 v193, v193, v193
  v_cvt_pk_bf16_f32 v194, v194, v194
  v_cvt_pk_bf16_f32 v195, v195, v195
  buffer_load_dwordx4 v[92:95], v1, s[48:51], s65 offen nt
  s_add_u32 s65, s65, 4096
  v_fma_f32 v196, v196, s70, v14
  v_fma_f32 v197, v197, s70, v14
  v_fma_f32 v198, v198, s70, v14
  v_fma_f32 v199, v199, s70, v14
  v_exp_f32 v196, v196
  v_exp_f32 v197, v197
  v_exp_f32 v198, v198
  v_exp_f32 v199, v199
  v_add_f32 v15, v15, v196
  v_add_f32 v16, v16, v197
  v_add_f32 v15, v15, v198
  v_add_f32 v16, v16, v199
  v_cvt_pk_bf16_f32 v196, v196, v196
  v_cvt_pk_bf16_f32 v197, v197, v197
  v_cvt_pk_bf16_f32 v198, v198, v198
  v_cvt_pk_bf16_f32 v199, v199, v199
  v_fma_f32 v200, v200, s70, v14
  v_fma_f32 v201, v201, s70, v14
  v_fma_f32 v202, v202, s70, v14
  v_fma_f32 v203, v203, s70, v14
  v_exp_f32 v200, v200
  v_exp_f32 v201, v201
  v_exp_f32 v202, v202
  v_exp_f32 v203, v203
  v_add_f32 v15, v15, v200
  v_add_f32 v16, v16, v201
  v_add_f32 v15, v15, v202
  v_add_f32 v16, v16, v203
  v_cvt_pk_bf16_f32 v200, v200, v200
  v_cvt_pk_bf16_f32 v201, v201, v201
  v_cvt_pk_bf16_f32 v202, v202, v202
  v_cvt_pk_bf16_f32 v203, v203, v203
  buffer_load_dwordx4 v[96:99], v1, s[48:51], s65 offen nt
  s_add_u32 s65, s65, 4096
  v_fma_f32 v204, v204, s70, v14
  v_fma_f32 v205, v205, s70, v14
  v_fma_f32 v206, v206, s70, v14
  v_fma_f32 v207, v207, s70, v14
  v_exp_f32 v204, v204
  v_exp_f32 v205, v205
  v_exp_f32 v206, v206
  v_exp_f32 v207, v207
  v_add_f32 v15, v15, v204
  v_add_f32 v16, v16, v205
  v_add_f32 v15, v15, v206
  v_add_f32 v16, v16, v207
  v_cvt_pk_bf16_f32 v204, v204, v204
  v_cvt_pk_bf16_f32 v205, v205, v205
  v_cvt_pk_bf16_f32 v206, v206, v206
  v_cvt_pk_bf16_f32 v207, v207, v207
  v_fma_f32 v208, v208, s70, v14
  v_fma_f32 v209, v209, s70, v14
  v_fma_f32 v210, v210, s70, v14
  v_fma_f32 v211, v211, s70, v14
  v_exp_f32 v208, v208
  v_exp_f32 v209, v209
  v_exp_f32 v210, v210
  v_exp_f32 v211, v211
  v_add_f32 v15, v15, v208
  v_add_f32 v16, v16, v209
  v_add_f32 v15, v15, v210
  v_add_f32 v16, v16, v211
  v_cvt_pk_bf16_f32 v208, v208, v208
  v_cvt_pk_bf16_f32 v209, v209, v209
  v_cvt_pk_bf16_f32 v210, v210, v210
  v_cvt_pk_bf16_f32 v211, v211, v211
  buffer_load_dwordx4 v[100:103], v1, s[48:51], s65 offen nt
  s_add_u32 s65, s65, 4096
  v_fma_f32 v212, v212, s70, v14
  v_fma_f32 v213, v213, s70, v14
  v_fma_f32 v214, v214, s70, v14
  v_fma_f32 v215, v215, s70, v14
  v_exp_f32 v212, v212
  v_exp_f32 v213, v213
  v_exp_f32 v214, v214
  v_exp_f32 v215, v215
  v_add_f32 v15, v15, v212
  v_add_f32 v16, v16, v213
  v_add_f32 v15, v15, v214
  v_add_f32 v16, v16, v215
  v_cvt_pk_bf16_f32 v212, v212, v212
  v_cvt_pk_bf16_f32 v213, v213, v213
  v_cvt_pk_bf16_f32 v214, v214, v214
  v_cvt_pk_bf16_f32 v215, v215, v215
  v_fma_f32 v216, v216, s70, v14
  v_fma_f32 v217, v217, s70, v14
  v_fma_f32 v218, v218, s70, v14
  v_fma_f32 v219, v219, s70, v14
  v_exp_f32 v216, v216
  v_exp_f32 v217, v217
  v_exp_f32 v218, v218
  v_exp_f32 v219, v219
  v_add_f32 v15, v15, v216
  v_add_f32 v16, v16, v217
  v_add_f32 v15, v15, v218
  v_add_f32 v16, v16, v219
  v_cvt_pk_bf16_f32 v216, v216, v216
  v_cvt_pk_bf16_f32 v217, v217, v217
  v_cvt_pk_bf16_f32 v218, v218, v218
  v_cvt_pk_bf16_f32 v219, v219, v219
  buffer_load_dwordx4 v[104:107], v1, s[48:51], s65 offen nt
  s_add_u32 s65, s65, 4096
  v_fma_f32 v220, v220, s70, v14
  v_fma_f32 v221, v221, s70, v14
  v_fma_f32 v222, v222, s70, v14
  v_fma_f32 v223, v223, s70, v14
  v_exp_f32 v220, v220
  v_exp_f32 v221, v221
  v_exp_f32 v222, v222
  v_exp_f32 v223, v223
  v_add_f32 v15, v15, v220
  v_add_f32 v16, v16, v221
  v_add_f32 v15, v15, v222
  v_add_f32 v16, v16, v223
  v_cvt_pk_bf16_f32 v220, v220, v220
  v_cvt_pk_bf16_f32 v221, v221, v221
  v_cvt_pk_bf16_f32 v222, v222, v222
  v_cvt_pk_bf16_f32 v223, v223, v223
  v_fma_f32 v224, v224, s70, v14
  v_fma_f32 v225, v225, s70, v14
  v_fma_f32 v226, v226, s70, v14
  v_fma_f32 v227, v227, s70, v14
  v_exp_f32 v224, v224
  v_exp_f32 v225, v225
  v_exp_f32 v226, v226
  v_exp_f32 v227, v227
  v_add_f32 v15, v15, v224
  v_add_f32 v16, v16, v225
  v_add_f32 v15, v15, v226
  v_add_f32 v16, v16, v227
  v_cvt_pk_bf16_f32 v224, v224, v224
  v_cvt_pk_bf16_f32 v225, v225, v225
  v_cvt_pk_bf16_f32 v226, v226, v226
  v_cvt_pk_bf16_f32 v227, v227, v227
  buffer_load_dwordx4 v[108:111], v1, s[48:51], s65 offen nt
  s_add_u32 s65, s65, 4096
  v_fma_f32 v228, v228, s70, v14
  v_fma_f32 v229, v229, s70, v14
  v_fma_f32 v230, v230, s70, v14
  v_fma_f32 v231, v231, s70, v14
  v_exp_f32 v228, v228
  v_exp_f32 v229, v229
  v_exp_f32 v230, v230
  v_exp_f32 v231, v231
  v_add_f32 v15, v15, v228
  v_add_f32 v16, v16, v229
  v_add_f32 v15, v15, v230
  v_add_f32 v16, v16, v231
  v_cvt_pk_bf16_f32 v228, v228, v228
  v_cvt_pk_bf16_f32 v229, v229, v229
  v_cvt_pk_bf16_f32 v230, v230, v230
  v_cvt_pk_bf16_f32 v231, v231, v231
  v_fma_f32 v232, v232, s70, v14
  v_fma_f32 v233, v233, s70, v14
  v_fma_f32 v234, v234, s70, v14
  v_fma_f32 v235, v235, s70, v14
  v_exp_f32 v232, v232
  v_exp_f32 v233, v233
  v_exp_f32 v234, v234
  v_exp_f32 v235, v235
  v_add_f32 v15, v15, v232
  v_add_f32 v16, v16, v233
  v_add_f32 v15, v15, v234
  v_add_f32 v16, v16, v235
  v_cvt_pk_bf16_f32 v232, v232, v232
  v_cvt_pk_bf16_f32 v233, v233, v233
  v_cvt_pk_bf16_f32 v234, v234, v234
  v_cvt_pk_bf16_f32 v235, v235, v235
  buffer_load_dwordx4 v[112:115], v1, s[48:51], s65 offen nt
  s_add_u32 s65, s65, 4096
  v_fma_f32 v236, v236, s70, v14
  v_fma_f32 v237, v237, s70, v14
  v_fma_f32 v238, v238, s70, v14
  v_fma_f32 v239, v239, s70, v14
  v_exp_f32 v236, v236
  v_exp_f32 v237, v237
  v_exp_f32 v238, v238
  v_exp_f32 v239, v239
  v_add_f32 v15, v15, v236
  v_add_f32 v16, v16, v237
  v_add_f32 v15, v15, v238
  v_add_f32 v16, v16, v239
  v_cvt_pk_bf16_f32 v236, v236, v236
  v_cvt_pk_bf16_f32 v237, v237, v237
  v_cvt_pk_bf16_f32 v238, v238, v238
  v_cvt_pk_bf16_f32 v239, v239, v239
  v_fma_f32 v240, v240, s70, v14
  v_fma_f32 v241, v241, s70, v14
  v_fma_f32 v242, v242, s70, v14
  v_fma_f32 v243, v243, s70, v14
  v_exp_f32 v240, v240
  v_exp_f32 v241, v241
  v_exp_f32 v242, v242
  v_exp_f32 v243, v243
  v_add_f32 v15, v15, v240
  v_add_f32 v16, v16, v241
  v_add_f32 v15, v15, v242
  v_add_f32 v16, v16, v243
  v_cvt_pk_bf16_f32 v240, v240, v240
  v_cvt_pk_bf16_f32 v241, v241, v241
  v_cvt_pk_bf16_f32 v242, v242, v242
  v_cvt_pk_bf16_f32 v243, v243, v243
  v_add_f32 v15, v15, v16
  v_mov_b32 v24, v15
  s_nop 1
  v_permlane16_swap_b32 v15, v24
  s_nop 0
  v_add_f32 v15, v15, v24
  v_mov_b32 v24, v15
  s_nop 1
  v_permlane32_swap_b32 v15, v24
  s_nop 0
  v_add_f32 v15, v15, v24
  v_mov_b32 v28, v13
  v_mov_b32 v29, v15
  v_mov_b32 v30, 1
  s_lshl_b32 s4, s14, 4
  s_add_u32 s4, s4, 3344
  v_mov_b32 v31, s4
  s_mov_b64 exec, 1
  ds_write_b64 v31, v[28:29]
  ds_write_b32 v31, v30 offset:8
  s_mov_b64 exec, -1
  v_and_b32 v36, v8, v180
  v_and_b32 v37, v9, v180
  v_and_b32 v38, v10, v180
  v_and_b32 v39, v11, v180
  v_and_b32 v40, v8, v181
  v_and_b32 v41, v9, v181
  v_and_b32 v42, v10, v181
  v_and_b32 v43, v11, v181
  v_and_b32 v44, v8, v182
  v_and_b32 v45, v9, v182
  v_and_b32 v46, v10, v182
  v_and_b32 v47, v11, v182
  v_and_b32 v48, v8, v183
  v_and_b32 v49, v9, v183
  v_and_b32 v50, v10, v183
  v_and_b32 v51, v11, v183
  s_waitcnt vmcnt(12)
  v_mfma_f32_16x16x32_bf16 v[32:35], v[52:55], v[36:39], 0
  v_mfma_f32_16x16x32_bf16 v[32:35], v[56:59], v[40:43], v[32:35]
  v_mfma_f32_16x16x32_bf16 v[32:35], v[60:63], v[44:47], v[32:35]
  v_mfma_f32_16x16x32_bf16 v[32:35], v[64:67], v[48:51], v[32:35]
  v_and_b32 v36, v8, v184
  v_and_b32 v37, v9, v184
  v_and_b32 v38, v10, v184
  v_and_b32 v39, v11, v184
  v_and_b32 v40, v8, v185
  v_and_b32 v41, v9, v185
  v_and_b32 v42, v10, v185
  v_and_b32 v43, v11, v185
  v_and_b32 v44, v8, v186
  v_and_b32 v45, v9, v186
  v_and_b32 v46, v10, v186
  v_and_b32 v47, v11, v186
  v_and_b32 v48, v8, v187
  v_and_b32 v49, v9, v187
  v_and_b32 v50, v10, v187
  v_and_b32 v51, v11, v187
  s_waitcnt vmcnt(8)
  v_mfma_f32_16x16x32_bf16 v[32:35], v[68:71], v[36:39], v[32:35]
  v_mfma_f32_16x16x32_bf16 v[32:35], v[72:75], v[40:43], v[32:35]
  v_mfma_f32_16x16x32_bf16 v[32:35], v[76:79], v[44:47], v[32:35]
  v_mfma_f32_16x16x32_bf16 v[32:35], v[80:83], v[48:51], v[32:35]
  v_and_b32 v36, v8, v188
  v_and_b32 v37, v9, v188
  v_and_b32 v38, v10, v188
  v_and_b32 v39, v11, v188
  v_and_b32 v40, v8, v189
  v_and_b32 v41, v9, v189
  v_and_b32 v42, v10, v189
  v_and_b32 v43, v11, v189
  v_and_b32 v44, v8, v190
  v_and_b32 v45, v9, v190
  v_and_b32 v46, v10, v190
  v_and_b32 v47, v11, v190
  v_and_b32 v48, v8, v191
  v_and_b32 v49, v9, v191
  v_and_b32 v50, v10, v191
  v_and_b32 v51, v11, v191
  s_waitcnt vmcnt(4)
  buffer_load_dwordx4 v[52:55], v1, s[48:51], s65 offen nt
  s_add_u32 s65, s65, 4096
  buffer_load_dwordx4 v[56:59], v1, s[48:51], s65 offen nt
  s_add_u32 s65, s65, 4096
  buffer_load_dwordx4 v[60:63], v1, s[48:51], s65 offen nt
  s_add_u32 s65, s65, 4096
  buffer_load_dwordx4 v[64:67], v1, s[48:51], s65 offen nt
  s_add_u32 s65, s65, 4096
  v_mfma_f32_16x16x32_bf16 v[32:35], v[84:87], v[36:39], v[32:35]
  v_mfma_f32_16x16x32_bf16 v[32:35], v[88:91], v[40:43], v[32:35]
  v_mfma_f32_16x16x32_bf16 v[32:35], v[92:95], v[44:47], v[32:35]
  v_mfma_f32_16x16x32_bf16 v[32:35], v[96:99], v[48:51], v[32:35]
  v_and_b32 v36, v8, v192
  v_and_b32 v37, v9, v192
  v_and_b32 v38, v10, v192
  v_and_b32 v39, v11, v192
  v_and_b32 v40, v8, v193
  v_and_b32 v41, v9, v193
  v_and_b32 v42, v10, v193
  v_and_b32 v43, v11, v193
  v_and_b32 v44, v8, v194
  v_and_b32 v45, v9, v194
  v_and_b32 v46, v10, v194
  v_and_b32 v47, v11, v194
  v_and_b32 v48, v8, v195
  v_and_b32 v49, v9, v195
  v_and_b32 v50, v10, v195
  v_and_b32 v51, v11, v195
  s_waitcnt vmcnt(4)
  buffer_load_dwordx4 v[68:71], v1, s[48:51], s65 offen nt
  s_add_u32 s65, s65, 4096
  buffer_load_dwordx4 v[72:75], v1, s[48:51], s65 offen nt
  s_add_u32 s65, s65, 4096
  buffer_load_dwordx4 v[76:79], v1, s[48:51], s65 offen nt
  s_add_u32 s65, s65, 4096
  buffer_load_dwordx4 v[80:83], v1, s[48:51], s65 offen nt
  s_add_u32 s65, s65, 4096
  v_mfma_f32_16x16x32_bf16 v[32:35], v[100:103], v[36:39], v[32:35]
  v_mfma_f32_16x16x32_bf16 v[32:35], v[104:107], v[40:43], v[32:35]
  v_mfma_f32_16x16x32_bf16 v[32:35], v[108:111], v[44:47], v[32:35]
  v_mfma_f32_16x16x32_bf16 v[32:35], v[112:115], v[48:51], v[32:35]
  v_and_b32 v36, v8, v196
  v_and_b32 v37, v9, v196
  v_and_b32 v38, v10, v196
  v_and_b32 v39, v11, v196
  v_and_b32 v40, v8, v197
  v_and_b32 v41, v9, v197
  v_and_b32 v42, v10, v197
  v_and_b32 v43, v11, v197
  v_and_b32 v44, v8, v198
  v_and_b32 v45, v9, v198
  v_and_b32 v46, v10, v198
  v_and_b32 v47, v11, v198
  v_and_b32 v48, v8, v199
  v_and_b32 v49, v9, v199
  v_and_b32 v50, v10, v199
  v_and_b32 v51, v11, v199
  s_waitcnt vmcnt(4)
  buffer_load_dwordx4 v[84:87], v1, s[48:51], s65 offen nt
  s_add_u32 s65, s65, 4096
  buffer_load_dwordx4 v[88:91], v1, s[48:51], s65 offen nt
  s_add_u32 s65, s65, 4096
  buffer_load_dwordx4 v[92:95], v1, s[48:51], s65 offen nt
  s_add_u32 s65, s65, 4096
  buffer_load_dwordx4 v[96:99], v1, s[48:51], s65 offen nt
  s_add_u32 s65, s65, 4096
  v_mfma_f32_16x16x32_bf16 v[32:35], v[52:55], v[36:39], v[32:35]
  v_mfma_f32_16x16x32_bf16 v[32:35], v[56:59], v[40:43], v[32:35]
  v_mfma_f32_16x16x32_bf16 v[32:35], v[60:63], v[44:47], v[32:35]
  v_mfma_f32_16x16x32_bf16 v[32:35], v[64:67], v[48:51], v[32:35]
  v_and_b32 v36, v8, v200
  v_and_b32 v37, v9, v200
  v_and_b32 v38, v10, v200
  v_and_b32 v39, v11, v200
  v_and_b32 v40, v8, v201
  v_and_b32 v41, v9, v201
  v_and_b32 v42, v10, v201
  v_and_b32 v43, v11, v201
  v_and_b32 v44, v8, v202
  v_and_b32 v45, v9, v202
  v_and_b32 v46, v10, v202
  v_and_b32 v47, v11, v202
  v_and_b32 v48, v8, v203
  v_and_b32 v49, v9, v203
  v_and_b32 v50, v10, v203
  v_and_b32 v51, v11, v203
  s_waitcnt vmcnt(4)
  buffer_load_dwordx4 v[100:103], v1, s[48:51], s65 offen nt
  s_add_u32 s65, s65, 4096
  buffer_load_dwordx4 v[104:107], v1, s[48:51], s65 offen nt
  s_add_u32 s65, s65, 4096
  buffer_load_dwordx4 v[108:111], v1, s[48:51], s65 offen nt
  s_add_u32 s65, s65, 4096
  buffer_load_dwordx4 v[112:115], v1, s[48:51], s65 offen nt
  s_add_u32 s65, s65, 4096
  v_mfma_f32_16x16x32_bf16 v[32:35], v[68:71], v[36:39], v[32:35]
  v_mfma_f32_16x16x32_bf16 v[32:35], v[72:75], v[40:43], v[32:35]
  v_mfma_f32_16x16x32_bf16 v[32:35], v[76:79], v[44:47], v[32:35]
  v_mfma_f32_16x16x32_bf16 v[32:35], v[80:83], v[48:51], v[32:35]
  v_and_b32 v36, v8, v204
  v_and_b32 v37, v9, v204
  v_and_b32 v38, v10, v204
  v_and_b32 v39, v11, v204
  v_and_b32 v40, v8, v205
  v_and_b32 v41, v9, v205
  v_and_b32 v42, v10, v205
  v_and_b32 v43, v11, v205
  v_and_b32 v44, v8, v206
  v_and_b32 v45, v9, v206
  v_and_b32 v46, v10, v206
  v_and_b32 v47, v11, v206
  v_and_b32 v48, v8, v207
  v_and_b32 v49, v9, v207
  v_and_b32 v50, v10, v207
  v_and_b32 v51, v11, v207
  s_waitcnt vmcnt(4)
  buffer_load_dwordx4 v[52:55], v1, s[48:51], s65 offen nt
  s_add_u32 s65, s65, 4096
  buffer_load_dwordx4 v[56:59], v1, s[48:51], s65 offen nt
  s_add_u32 s65, s65, 4096
  buffer_load_dwordx4 v[60:63], v1, s[48:51], s65 offen nt
  s_add_u32 s65, s65, 4096
  buffer_load_dwordx4 v[64:67], v1, s[48:51], s65 offen nt
  s_add_u32 s65, s65, 4096
  v_mfma_f32_16x16x32_bf16 v[32:35], v[84:87], v[36:39], v[32:35]
  v_mfma_f32_16x16x32_bf16 v[32:35], v[88:91], v[40:43], v[32:35]
  v_mfma_f32_16x16x32_bf16 v[32:35], v[92:95], v[44:47], v[32:35]
  v_mfma_f32_16x16x32_bf16 v[32:35], v[96:99], v[48:51], v[32:35]
  v_and_b32 v36, v8, v208
  v_and_b32 v37, v9, v208
  v_and_b32 v38, v10, v208
  v_and_b32 v39, v11, v208
  v_and_b32 v40, v8, v209
  v_and_b32 v41, v9, v209
  v_and_b32 v42, v10, v209
  v_and_b32 v43, v11, v209
  v_and_b32 v44, v8, v210
  v_and_b32 v45, v9, v210
  v_and_b32 v46, v10, v210
  v_and_b32 v47, v11, v210
  v_and_b32 v48, v8, v211
  v_and_b32 v49, v9, v211
  v_and_b32 v50, v10, v211
  v_and_b32 v51, v11, v211
  s_waitcnt vmcnt(4)
  buffer_load_dwordx4 v[68:71], v1, s[48:51], s65 offen nt
  s_add_u32 s65, s65, 4096
  buffer_load_dwordx4 v[72:75], v1, s[48:51], s65 offen nt
  s_add_u32 s65, s65, 4096
  buffer_load_dwordx4 v[76:79], v1, s[48:51], s65 offen nt
  s_add_u32 s65, s65, 4096
  buffer_load_dwordx4 v[80:83], v1, s[48:51], s65 offen nt
  s_add_u32 s65, s65, 4096
  v_mfma_f32_16x16x32_bf16 v[32:35], v[100:103], v[36:39], v[32:35]
  v_mfma_f32_16x16x32_bf16 v[32:35], v[104:107], v[40:43], v[32:35]
  v_mfma_f32_16x16x32_bf16 v[32:35], v[108:111], v[44:47], v[32:35]
  v_mfma_f32_16x16x32_bf16 v[32:35], v[112:115], v[48:51], v[32:35]
  v_and_b32 v36, v8, v212
  v_and_b32 v37, v9, v212
  v_and_b32 v38, v10, v212
  v_and_b32 v39, v11, v212
  v_and_b32 v40, v8, v213
  v_and_b32 v41, v9, v213
  v_and_b32 v42, v10, v213
  v_and_b32 v43, v11, v213
  v_and_b32 v44, v8, v214
  v_and_b32 v45, v9, v214
  v_and_b32 v46, v10, v214
  v_and_b32 v47, v11, v214
  v_and_b32 v48, v8, v215
  v_and_b32 v49, v9, v215
  v_and_b32 v50, v10, v215
  v_and_b32 v51, v11, v215
  s_waitcnt vmcnt(4)
  buffer_load_dwordx4 v[84:87], v1, s[48:51], s65 offen nt
  s_add_u32 s65, s65, 4096
  buffer_load_dwordx4 v[88:91], v1, s[48:51], s65 offen nt
  s_add_u32 s65, s65, 4096
  buffer_load_dwordx4 v[92:95], v1, s[48:51], s65 offen nt
  s_add_u32 s65, s65, 4096
  buffer_load_dwordx4 v[96:99], v1, s[48:51], s65 offen nt
  s_add_u32 s65, s65, 4096
  buffer_load_dwordx4 v[100:103], v1, s[48:51], s65 offen nt
  s_add_u32 s65, s65, 4096
  buffer_load_dwordx4 v[104:107], v1, s[48:51], s65 offen nt
  s_add_u32 s65, s65, 4096
  buffer_load_dwordx4 v[108:111], v1, s[48:51], s65 offen nt
  s_add_u32 s65, s65, 4096
  buffer_load_dwordx4 v[112:115], v1, s[48:51], s65 offen nt
  s_add_u32 s65, s65, 4096
  v_mfma_f32_16x16x32_bf16 v[32:35], v[52:55], v[36:39], v[32:35]
  v_mfma_f32_16x16x32_bf16 v[32:35], v[56:59], v[40:43], v[32:35]
  v_mfma_f32_16x16x32_bf16 v[32:35], v[60:63], v[44:47], v[32:35]
  v_mfma_f32_16x16x32_bf16 v[32:35], v[64:67], v[48:51], v[32:35]
  v_mov_b32 v30, 4
  s_mov_b64 exec, 1
  ds_write_b32 v20, v30
  s_mov_b64 exec, -1
  v_and_b32 v36, v8, v216
  v_and_b32 v37, v9, v216
  v_and_b32 v38, v10, v216
  v_and_b32 v39, v11, v216
  v_and_b32 v40, v8, v217
  v_and_b32 v41, v9, v217
  v_and_b32 v42, v10, v217
  v_and_b32 v43, v11, v217
  v_and_b32 v44, v8, v218
  v_and_b32 v45, v9, v218
  v_and_b32 v46, v10, v218
  v_and_b32 v47, v11, v218
  v_and_b32 v48, v8, v219
  v_and_b32 v49, v9, v219
  v_and_b32 v50, v10, v219
  v_and_b32 v51, v11, v219
  s_waitcnt vmcnt(8)
  buffer_load_dwordx4 v[52:55], v1, s[48:51], s65 offen nt
  s_add_u32 s65, s65, 4096
  buffer_load_dwordx4 v[56:59], v1, s[48:51], s65 offen nt
  s_add_u32 s65, s65, 4096
  buffer_load_dwordx4 v[60:63], v1, s[48:51], s65 offen nt
  s_add_u32 s65, s65, 4096
  buffer_load_dwordx4 v[64:67], v1, s[48:51], s65 offen nt
  s_add_u32 s65, s65, 4096
  v_mfma_f32_16x16x32_bf16 v[32:35], v[68:71], v[36:39], v[32:35]
  v_mfma_f32_16x16x32_bf16 v[32:35], v[72:75], v[40:43], v[32:35]
  v_mfma_f32_16x16x32_bf16 v[32:35], v[76:79], v[44:47], v[32:35]
  v_mfma_f32_16x16x32_bf16 v[32:35], v[80:83], v[48:51], v[32:35]
  v_and_b32 v36, v8, v220
  v_and_b32 v37, v9, v220
  v_and_b32 v38, v10, v220
  v_and_b32 v39, v11, v220
  v_and_b32 v40, v8, v221
  v_and_b32 v41, v9, v221
  v_and_b32 v42, v10, v221
  v_and_b32 v43, v11, v221
  v_and_b32 v44, v8, v222
  v_and_b32 v45, v9, v222
  v_and_b32 v46, v10, v222
  v_and_b32 v47, v11, v222
  v_and_b32 v48, v8, v223
  v_and_b32 v49, v9, v223
  v_and_b32 v50, v10, v223
  v_and_b32 v51, v11, v223
  s_waitcnt vmcnt(8)
  buffer_load_dwordx4 v[68:71], v1, s[48:51], s65 offen nt
  s_add_u32 s65, s65, 4096
  buffer_load_dwordx4 v[72:75], v1, s[48:51], s65 offen nt
  s_add_u32 s65, s65, 4096
  buffer_load_dwordx4 v[76:79], v1, s[48:51], s65 offen nt
  s_add_u32 s65, s65, 4096
  buffer_load_dwordx4 v[80:83], v1, s[48:51], s65 offen nt
  s_add_u32 s65, s65, 4096
  v_mfma_f32_16x16x32_bf16 v[32:35], v[84:87], v[36:39], v[32:35]
  v_mfma_f32_16x16x32_bf16 v[32:35], v[88:91], v[40:43], v[32:35]
  v_mfma_f32_16x16x32_bf16 v[32:35], v[92:95], v[44:47], v[32:35]
  v_mfma_f32_16x16x32_bf16 v[32:35], v[96:99], v[48:51], v[32:35]
  v_and_b32 v36, v8, v224
  v_and_b32 v37, v9, v224
  v_and_b32 v38, v10, v224
  v_and_b32 v39, v11, v224
  v_and_b32 v40, v8, v225
  v_and_b32 v41, v9, v225
  v_and_b32 v42, v10, v225
  v_and_b32 v43, v11, v225
  v_and_b32 v44, v8, v226
  v_and_b32 v45, v9, v226
  v_and_b32 v46, v10, v226
  v_and_b32 v47, v11, v226
  v_and_b32 v48, v8, v227
  v_and_b32 v49, v9, v227
  v_and_b32 v50, v10, v227
  v_and_b32 v51, v11, v227
  s_waitcnt vmcnt(8)
  buffer_load_dwordx4 v[84:87], v1, s[48:51], s65 offen nt
  s_add_u32 s65, s65, 4096
  buffer_load_dwordx4 v[88:91], v1, s[48:51], s65 offen nt
  s_add_u32 s65, s65, 4096
  buffer_load_dwordx4 v[92:95], v1, s[48:51], s65 offen nt
  s_add_u32 s65, s65, 4096
  buffer_load_dwordx4 v[96:99], v1, s[48:51], s65 offen nt
  s_add_u32 s65, s65, 4096
  v_mfma_f32_16x16x32_bf16 v[32:35], v[100:103], v[36:39], v[32:35]
  v_mfma_f32_16x16x32_bf16 v[32:35], v[104:107], v[40:43], v[32:35]
  v_mfma_f32_16x16x32_bf16 v[32:35], v[108:111], v[44:47], v[32:35]
  v_mfma_f32_16x16x32_bf16 v[32:35], v[112:115], v[48:51], v[32:35]
  v_and_b32 v36, v8, v228
  v_and_b32 v37, v9, v228
  v_and_b32 v38, v10, v228
  v_and_b32 v39, v11, v228
  v_and_b32 v40, v8, v229
  v_and_b32 v41, v9, v229
  v_and_b32 v42, v10, v229
  v_and_b32 v43, v11, v229
  v_and_b32 v44, v8, v230
  v_and_b32 v45, v9, v230
  v_and_b32 v46, v10, v230
  v_and_b32 v47, v11, v230
  v_and_b32 v48, v8, v231
  v_and_b32 v49, v9, v231
  v_and_b32 v50, v10, v231
  v_and_b32 v51, v11, v231
  s_waitcnt vmcnt(8)
  buffer_load_dwordx4 v[100:103], v1, s[48:51], s65 offen nt
  s_add_u32 s65, s65, 4096
  buffer_load_dwordx4 v[104:107], v1, s[48:51], s65 offen nt
  s_add_u32 s65, s65, 4096
  buffer_load_dwordx4 v[108:111], v1, s[48:51], s65 offen nt
  s_add_u32 s65, s65, 4096
  buffer_load_dwordx4 v[112:115], v1, s[48:51], s65 offen nt
  s_cmp_lg_u32 s13, 1
  s_cbranch_scc1 L_vB
  v_mfma_f32_16x16x32_bf16 v[32:35], v[52:55], v[36:39], v[32:35]
  v_mfma_f32_16x16x32_bf16 v[32:35], v[56:59], v[40:43], v[32:35]
  v_mfma_f32_16x16x32_bf16 v[32:35], v[60:63], v[44:47], v[32:35]
  v_mfma_f32_16x16x32_bf16 v[32:35], v[64:67], v[48:51], v[32:35]
  s_mul_i32 s68, s11, 73728
  s_mul_i32 s67, s12, 384
  s_add_u32 s68, s68, s67
  s_mul_i32 s67, s14, 9216
  s_add_u32 s68, s68, s67
  s_lshl_b32 s69, s14, 10
  s_add_u32 s69, s69, 47360
  s_add_u32 s66, s68, 0
  s_add_u32 m0, s69, 0
  s_nop 0
  buffer_load_dwordx4 v3, s[56:59], s66 offen nt lds
  s_add_u32 s66, s68, 36864
  s_add_u32 m0, s69, 4096
  s_nop 0
  buffer_load_dwordx4 v3, s[56:59], s66 offen nt lds
  s_add_u32 s66, s68, 128
  s_add_u32 m0, s69, 8192
  s_nop 0
  buffer_load_dwordx4 v3, s[56:59], s66 offen nt lds
  s_add_u32 s66, s68, 36992
  s_add_u32 m0, s69, 12288
  s_nop 0
  buffer_load_dwordx4 v3, s[56:59], s66 offen nt lds
  s_add_u32 s66, s68, 256
  s_add_u32 m0, s69, 16384
  s_nop 0
  buffer_load_dwordx4 v3, s[56:59], s66 offen nt lds
  s_add_u32 s66, s68, 37120
  s_add_u32 m0, s69, 20480
  s_nop 0
  buffer_load_dwordx4 v3, s[56:59], s66 offen nt lds
  v_and_b32 v36, v8, v232
  v_and_b32 v37, v9, v232
  v_and_b32 v38, v10, v232
  v_and_b32 v39, v11, v232
  v_and_b32 v40, v8, v233
  v_and_b32 v41, v9, v233
  v_and_b32 v42, v10, v233
  v_and_b32 v43, v11, v233
  v_and_b32 v44, v8, v234
  v_and_b32 v45, v9, v234
  v_and_b32 v46, v10, v234
  v_and_b32 v47, v11, v234
  v_and_b32 v48, v8, v235
  v_and_b32 v49, v9, v235
  v_and_b32 v50, v10, v235
  v_and_b32 v51, v11, v235
  s_waitcnt vmcnt(14)
  v_mfma_f32_16x16x32_bf16 v[32:35], v[68:71], v[36:39], v[32:35]
  v_mfma_f32_16x16x32_bf16 v[32:35], v[72:75], v[40:43], v[32:35]
  v_mfma_f32_16x16x32_bf16 v[32:35], v[76:79], v[44:47], v[32:35]
  v_mfma_f32_16x16x32_bf16 v[32:35], v[80:83], v[48:51], v[32:35]
  v_and_b32 v36, v8, v236
  v_and_b32 v37, v9, v236
  v_and_b32 v38, v10, v236
  v_and_b32 v39, v11, v236
  v_and_b32 v40, v8, v237
  v_and_b32 v41, v9, v237
  v_and_b32 v42, v10, v237
  v_and_b32 v43, v11, v237
  v_and_b32 v44, v8, v238
  v_and_b32 v45, v9, v238
  v_and_b32 v46, v10, v238
  v_and_b32 v47, v11, v238
  v_and_b32 v48, v8, v239
  v_and_b32 v49, v9, v239
  v_and_b32 v50, v10, v239
  v_and_b32 v51, v11, v239
  s_waitcnt vmcnt(10)
  v_mfma_f32_16x16x32_bf16 v[32:35], v[84:87], v[36:39], v[32:35]
  v_mfma_f32_16x16x32_bf16 v[32:35], v[88:91], v[40:43], v[32:35]
  v_mfma_f32_16x16x32_bf16 v[32:35], v[92:95], v[44:47], v[32:35]
  v_mfma_f32_16x16x32_bf16 v[32:35], v[96:99], v[48:51], v[32:35]
  v_and_b32 v36, v8, v240
  v_and_b32 v37, v9, v240
  v_and_b32 v38, v10, v240
  v_and_b32 v39, v11, v240
  v_and_b32 v40, v8, v241
  v_and_b32 v41, v9, v241
  v_and_b32 v42, v10, v241
  v_and_b32 v43, v11, v241
  v_and_b32 v44, v8, v242
  v_and_b32 v45, v9, v242
  v_and_b32 v46, v10, v242
  v_and_b32 v47, v11, v242
  v_and_b32 v48, v8, v243
  v_and_b32 v49, v9, v243
  v_and_b32 v50, v10, v243
  v_and_b32 v51, v11, v243
  s_waitcnt vmcnt(9)
  v_mfma_f32_16x16x32_bf16 v[32:35], v[100:103], v[36:39], v[32:35]
  s_waitcnt vmcnt(8)
  v_mfma_f32_16x16x32_bf16 v[32:35], v[104:107], v[40:43], v[32:35]
  s_waitcnt vmcnt(7)
  v_mfma_f32_16x16x32_bf16 v[32:35], v[108:111], v[44:47], v[32:35]
  s_waitcnt vmcnt(6)
  v_mfma_f32_16x16x32_bf16 v[32:35], v[112:115], v[48:51], v[32:35]
  s_branch L_vdone
L_vB:
  v_mfma_f32_16x16x32_bf16 v[32:35], v[52:55], v[36:39], v[32:35]
  v_mfma_f32_16x16x32_bf16 v[32:35], v[56:59], v[40:43], v[32:35]
  v_mfma_f32_16x16x32_bf16 v[32:35], v[60:63], v[44:47], v[32:35]
  v_mfma_f32_16x16x32_bf16 v[32:35], v[64:67], v[48:51], v[32:35]
  v_and_b32 v36, v8, v232
  v_and_b32 v37, v9, v232
  v_and_b32 v38, v10, v232
  v_and_b32 v39, v11, v232
  v_and_b32 v40, v8, v233
  v_and_b32 v41, v9, v233
  v_and_b32 v42, v10, v233
  v_and_b32 v43, v11, v233
  v_and_b32 v44, v8, v234
  v_and_b32 v45, v9, v234
  v_and_b32 v46, v10, v234
  v_and_b32 v47, v11, v234
  v_and_b32 v48, v8, v235
  v_and_b32 v49, v9, v235
  v_and_b32 v50, v10, v235
  v_and_b32 v51, v11, v235
  s_waitcnt vmcnt(8)
  v_mfma_f32_16x16x32_bf16 v[32:35], v[68:71], v[36:39], v[32:35]
  v_mfma_f32_16x16x32_bf16 v[32:35], v[72:75], v[40:43], v[32:35]
  v_mfma_f32_16x16x32_bf16 v[32:35], v[76:79], v[44:47], v[32:35]
  v_mfma_f32_16x16x32_bf16 v[32:35], v[80:83], v[48:51], v[32:35]
  v_and_b32 v36, v8, v236
  v_and_b32 v37, v9, v236
  v_and_b32 v38, v10, v236
  v_and_b32 v39, v11, v236
  v_and_b32 v40, v8, v237
  v_and_b32 v41, v9, v237
  v_and_b32 v42, v10, v237
  v_and_b32 v43, v11, v237
  v_and_b32 v44, v8, v238
  v_and_b32 v45, v9, v238
  v_and_b32 v46, v10, v238
  v_and_b32 v47, v11, v238
  v_and_b32 v48, v8, v239
  v_and_b32 v49, v9, v239
  v_and_b32 v50, v10, v239
  v_and_b32 v51, v11, v239
  s_waitcnt vmcnt(4)
  v_mfma_f32_16x16x32_bf16 v[32:35], v[84:87], v[36:39], v[32:35]
  v_mfma_f32_16x16x32_bf16 v[32:35], v[88:91], v[40:43], v[32:35]
  v_mfma_f32_16x16x32_bf16 v[32:35], v[92:95], v[44:47], v[32:35]
  v_mfma_f32_16x16x32_bf16 v[32:35], v[96:99], v[48:51], v[32:35]
  v_and_b32 v36, v8, v240
  v_and_b32 v37, v9, v240
  v_and_b32 v38, v10, v240
  v_and_b32 v39, v11, v240
  v_and_b32 v40, v8, v241
  v_and_b32 v41, v9, v241
  v_and_b32 v42, v10, v241
  v_and_b32 v43, v11, v241
  v_and_b32 v44, v8, v242
  v_and_b32 v45, v9, v242
  v_and_b32 v46, v10, v242
  v_and_b32 v47, v11, v242
  v_and_b32 v48, v8, v243
  v_and_b32 v49, v9, v243
  v_and_b32 v50, v10, v243
  v_and_b32 v51, v11, v243
  s_waitcnt vmcnt(3)
  v_mfma_f32_16x16x32_bf16 v[32:35], v[100:103], v[36:39], v[32:35]
  s_waitcnt vmcnt(2)
  v_mfma_f32_16x16x32_bf16 v[32:35], v[104:107], v[40:43], v[32:35]
  s_waitcnt vmcnt(1)
  v_mfma_f32_16x16x32_bf16 v[32:35], v[108:111], v[44:47], v[32:35]
  s_waitcnt vmcnt(0)
  v_mfma_f32_16x16x32_bf16 v[32:35], v[112:115], v[48:51], v[32:35]
L_vdone:
  s_mul_i32 s66, s7, 147456
  s_lshl_b32 s67, s9, 7
  s_add_u32 s66, s66, s67
  s_mul_i32 s68, s14, 9216
  s_add_u32 s66, s66, s68
  s_lshl_b32 s69, s14, 10
  s_add_u32 s67, s69, 6400
  s_mov_b32 m0, s67
  s_nop 0
  buffer_load_dwordx4 v3, s[60:63], s66 offen nt lds
  s_add_u32 s66, s66, 36864
  s_add_u32 s67, s67, 4096
  s_mov_b32 m0, s67
  s_nop 0
  buffer_load_dwordx4 v3, s[60:63], s66 offen nt lds
  s_add_u32 s66, s66, 36864
  s_add_u32 s67, s67, 4096
  s_mov_b32 m0, s67
  s_nop 0
  buffer_load_dwordx4 v3, s[60:63], s66 offen nt lds
  s_add_u32 s66, s66, 36864
  s_add_u32 s67, s67, 4096
  s_mov_b32 m0, s67
  s_nop 0
  buffer_load_dwordx4 v3, s[60:63], s66 offen nt lds
  s_mov_b32 exec_lo, 0x00ff00ff
  s_mov_b32 exec_hi, 0x00ff00ff
  s_nop 0
  ds_write_b32 v17, v32 offset:0
  ds_write_b32 v17, v33 offset:32
  ds_write_b32 v17, v34 offset:64
  ds_write_b32 v17, v35 offset:96
  s_mov_b64 exec, -1
  s_waitcnt lgkmcnt(0)
  s_barrier
  v_lshrrev_b32 v24, 4, v0
  v_lshlrev_b32 v24, 3, v24
  v_bfe_u32 v25, v0, 2, 2
  v_add_u32 v24, v24, v25
  v_lshlrev_b32 v24, 7, v24
  v_and_b32 v25, 3, v0
  v_lshlrev_b32 v25, 3, v25
  v_add_u32 v24, v24, v25
  s_lshl_b32 s4, s14, 5
  v_add_u32 v26, s4, v24
  s_cmp_lg_u32 s13, 2
  s_cbranch_scc1 L_s_no2c
  ds_read_b64_tr_b16 v[132:133], v26 offset:22784
  ds_read_b64_tr_b16 v[134:135], v26 offset:23296
  ds_read_b64_tr_b16 v[136:137], v26 offset:26880
  ds_read_b64_tr_b16 v[138:139], v26 offset:27392
  ds_read_b64_tr_b16 v[140:141], v26 offset:30976
  ds_read_b64_tr_b16 v[142:143], v26 offset:31488
  ds_read_b64_tr_b16 v[144:145], v26 offset:35072
  ds_read_b64_tr_b16 v[146:147], v26 offset:35584
L_s_no2c:
  s_cmp_lg_u32 s13, 1
  s_cbranch_scc1 L_s_now2
  v_and_b32 v28, 3, v0
  v_lshlrev_b32 v29, 7, v28
  v_add_u32 v29, 2816, v29
  v_cmp_gt_u32 vcc, 2, v28
  v_mov_b32 v30, 2304
  s_nop 0
  v_cndmask_b32 v29, v30, v29, vcc
  v_lshrrev_b32 v30, 4, v0
  v_lshlrev_b32 v30, 4, v30
  v_add_u32 v27, v29, v30
  v_add_u32 v17, 47360, v26
  s_mul_i32 s4, s11, 4608
  s_mul_i32 s5, s12, 1536
  s_add_u32 s4, s4, s5
  s_lshl_b32 s5, s14, 7
  s_add_u32 s4, s4, s5
  s_add_u32 s4, s4, 524288
  v_lshrrev_b32 v1, 1, v0
  v_lshlrev_b32 v1, 4, v1
  v_add_u32 v1, s4, v1
  ds_read_b128 v[68:71], v27 offset:0
  ds_read_b128 v[72:75], v27 offset:64
  s_lshl_b32 s4, s14, 2
  s_add_u32 s4, s4, 3408
  v_mov_b32 v2, s4
  v_mov_b32 v13, 1
  v_and_b32 v14, 3, v0
  v_lshlrev_b32 v14, 2, v14
  s_waitcnt vmcnt(4)
  s_mov_b64 exec, 1
  ds_write_b32 v2, v13
  s_mov_b64 exec, -1
  s_mov_b32 s66, 1600000
L_w2f:
  ds_read_b32 v15, v14 offset:3408
  s_waitcnt lgkmcnt(0)
  v_cmp_ne_u32 vcc, 1, v15
  s_nop 1
  s_cmp_eq_u64 vcc, 0
  s_cbranch_scc1 L_w2fd
  s_sub_u32 s66, s66, 1
  s_cmp_lg_u32 s66, 0
  s_cbranch_scc1 L_w2f
L_w2fd:
  ds_read_b64_tr_b16 v[84:85], v17 offset:0
  ds_read_b64_tr_b16 v[86:87], v17 offset:512
  ds_read_b64_tr_b16 v[88:89], v17 offset:4096
  ds_read_b64_tr_b16 v[90:91], v17 offset:4608
  ds_read_b64_tr_b16 v[92:93], v17 offset:8192
  ds_read_b64_tr_b16 v[94:95], v17 offset:8704
  ds_read_b64_tr_b16 v[96:97], v17 offset:12288
  ds_read_b64_tr_b16 v[98:99], v17 offset:12800
  ds_read_b64_tr_b16 v[100:101], v17 offset:16384
  ds_read_b64_tr_b16 v[102:103], v17 offset:16896
  ds_read_b64_tr_b16 v[104:105], v17 offset:20480
  ds_read_b64_tr_b16 v[106:107], v17 offset:20992
  s_waitcnt lgkmcnt(8)
  v_mfma_f32_16x16x32_bf16 v[148:151], v[68:71], v[84:87], 0
  v_mfma_f32_16x16x32_bf16 v[148:151], v[72:75], v[88:91], v[148:151]
  s_waitcnt lgkmcnt(4)
  v_mfma_f32_16x16x32_bf16 v[152:155], v[68:71], v[92:95], 0
  v_mfma_f32_16x16x32_bf16 v[152:155], v[72:75], v[96:99], v[152:155]
  s_waitcnt lgkmcnt(0)
  v_mfma_f32_16x16x32_bf16 v[156:159], v[68:71], v[100:103], 0
  v_mfma_f32_16x16x32_bf16 v[156:159], v[72:75], v[104:107], v[156:159]
  s_nop 5
  s_nop 1
  v_mov_b32_dpp v36, v148 quad_perm:[1,0,3,2] row_mask:0xf bank_mask:0xf
  v_mov_b32_dpp v37, v149 quad_perm:[1,0,3,2] row_mask:0xf bank_mask:0xf
  v_perm_b32 v40, v148, v37, s26
  v_perm_b32 v41, v149, v37, s27
  v_perm_b32 v42, v36, v37, s38
  v_mov_b32 v43, v12
  v_mov_b32_dpp v36, v152 quad_perm:[1,0,3,2] row_mask:0xf bank_mask:0xf
  v_mov_b32_dpp v37, v153 quad_perm:[1,0,3,2] row_mask:0xf bank_mask:0xf
  v_perm_b32 v44, v152, v37, s26
  v_perm_b32 v45, v153, v37, s27
  v_perm_b32 v46, v36, v37, s38
  v_mov_b32 v47, v12
  v_mov_b32_dpp v36, v156 quad_perm:[1,0,3,2] row_mask:0xf bank_mask:0xf
  v_mov_b32_dpp v37, v157 quad_perm:[1,0,3,2] row_mask:0xf bank_mask:0xf
  v_perm_b32 v48, v156, v37, s26
  v_perm_b32 v49, v157, v37, s27
  v_perm_b32 v50, v36, v37, s38
  v_mov_b32 v51, v12
  s_waitcnt vmcnt(0) lgkmcnt(0)
  s_mov_b64 exec, 0x5555
  global_store_dwordx4 v1, v[40:43], s[40:41] offset:0 sc1
  global_store_dwordx4 v1, v[44:47], s[40:41] offset:512 sc1
  global_store_dwordx4 v1, v[48:51], s[40:41] offset:1024 sc1
  s_mov_b64 exec, -1
  s_branch L_s_b3
L_s_now2:
  s_waitcnt vmcnt(0) lgkmcnt(0)
L_s_b3:
  s_lshl_b32 s4, s14, 2
  s_add_u32 s4, s4, 3424
  v_mov_b32 v2, s4
  v_mov_b32 v13, 1
  v_and_b32 v14, 3, v0
  v_lshlrev_b32 v14, 2, v14
  s_mov_b64 exec, 1
  ds_write_b32 v2, v13
  s_mov_b64 exec, -1
  s_mov_b32 s66, 1600000
L_wof:
  ds_read_b32 v15, v14 offset:3424
  s_waitcnt lgkmcnt(0)
  v_cmp_ne_u32 vcc, 1, v15
  s_nop 1
  s_cmp_eq_u64 vcc, 0
  s_cbranch_scc1 L_wofd
  s_sub_u32 s66, s66, 1
  s_cmp_lg_u32 s66, 0
  s_cbranch_scc1 L_wof
L_wofd:
  ds_read_b64_tr_b16 v[116:117], v26 offset:6400
  ds_read_b64_tr_b16 v[118:119], v26 offset:6912
  ds_read_b64_tr_b16 v[120:121], v26 offset:10496
  ds_read_b64_tr_b16 v[122:123], v26 offset:11008
  ds_read_b64_tr_b16 v[124:125], v26 offset:14592
  ds_read_b64_tr_b16 v[126:127], v26 offset:15104
  ds_read_b64_tr_b16 v[128:129], v26 offset:18688
  ds_read_b64_tr_b16 v[130:131], v26 offset:19200
  s_waitcnt lgkmcnt(0)
  s_barrier
  ds_read_b128 v[52:55], v18 offset:0
  ds_read_b128 v[56:59], v18 offset:64
  ds_read_b128 v[60:63], v18 offset:128
  ds_read_b128 v[64:67], v18 offset:192
  s_cmp_lg_u32 s13, 2
  s_cbranch_scc1 L_s_no2b
  s_waitcnt lgkmcnt(0)
  v_mfma_f32_16x16x32_bf16 v[36:39], v[52:55], v[132:135], 0
  v_mfma_f32_16x16x32_bf16 v[36:39], v[56:59], v[136:139], v[36:39]
  v_mfma_f32_16x16x32_bf16 v[36:39], v[60:63], v[140:143], v[36:39]
  v_mfma_f32_16x16x32_bf16 v[36:39], v[64:67], v[144:147], v[36:39]
  s_nop 7
  v_mov_b32_dpp v24, v36 quad_perm:[1,0,3,2] row_mask:0xf bank_mask:0xf
  v_mov_b32_dpp v25, v37 quad_perm:[1,0,3,2] row_mask:0xf bank_mask:0xf
  v_perm_b32 v28, v36, v25, s26
  v_perm_b32 v29, v37, v25, s27
  v_perm_b32 v30, v24, v25, s38
  v_mov_b32 v31, v12
  s_mov_b64 exec, 0x5555
  global_store_dwordx4 v19, v[28:31], s[40:41] offset:512 sc1
  s_mov_b64 exec, -1
  s_nop 0
L_s_no2b:
  s_waitcnt lgkmcnt(3)
  v_mfma_f32_16x16x32_bf16 v[32:35], v[52:55], v[116:119], 0
  s_waitcnt lgkmcnt(2)
  v_mfma_f32_16x16x32_bf16 v[32:35], v[56:59], v[120:123], v[32:35]
  s_waitcnt lgkmcnt(1)
  v_mfma_f32_16x16x32_bf16 v[32:35], v[60:63], v[124:127], v[32:35]
  s_waitcnt lgkmcnt(0)
  v_mfma_f32_16x16x32_bf16 v[32:35], v[64:67], v[128:131], v[32:35]
  s_nop 7
  v_mov_b32_dpp v24, v32 quad_perm:[1,0,3,2] row_mask:0xf bank_mask:0xf
  v_mov_b32_dpp v25, v33 quad_perm:[1,0,3,2] row_mask:0xf bank_mask:0xf
  v_perm_b32 v28, v32, v25, s26
  v_perm_b32 v29, v33, v25, s27
  v_perm_b32 v30, v24, v25, s38
  v_mov_b32 v31, v12
  s_mov_b64 exec, 0x5555
  global_store_dwordx4 v19, v[28:31], s[40:41] offset:0 sc1
  s_mov_b64 exec, -1
L_fin:
L_end:
  s_endpgm
L_srv2:
  s_mul_i32 s10, s7, 7
  s_add_u32 s10, s10, s9
  s_mul_i32 s11, s10, 171
  s_lshr_b32 s11, s11, 9
  s_mul_i32 s12, s11, 3
  s_sub_u32 s12, s10, s12
  s_cmp_lt_u32 s10, 216
  s_cselect_b32 s13, 1, 0
  s_cmp_eq_u32 s9, 7
  s_cselect_b32 s13, 2, s13
  s_mov_b32 s56, s30
  s_mov_b32 s57, s31
  s_mov_b32 s58, 9216
  s_mov_b32 s59, 0x00020000
  s_mov_b32 s60, s34
  s_mov_b32 s61, s35
  s_mov_b32 s62, 1152
  s_mov_b32 s63, 0x00020000
  s_mov_b32 s64, s16
  s_mov_b32 s65, s17
  s_mov_b32 s66, 2304
  s_mov_b32 s67, 0x00020000
  s_mov_b32 s26, 0x07060503
  s_mov_b32 s27, 0x07060502
  s_mov_b32 s38, 0x07060501
  s_mov_b32 s39, 0x04000c0c
  s_mov_b32 s15, 0x0706000c
  s_lshl_b32 s49, s11, 7
  v_and_b32 v16, 31, v0
  v_lshlrev_b32 v16, 2, v16
  buffer_load_dword v11, v16, s[56:59], s49 offen
  v_and_b32 v16, 1, v0
  v_lshlrev_b32 v16, 1, v16
  v_bfe_u32 v20, v0, 2, 1
  v_add_u32 v16, v16, v20
  s_lshl_b32 s49, s2, 2
  v_add_u32 v16, s49, v16
  v_lshlrev_b32 v17, 1, v16
  buffer_load_ushort v12, v17, s[60:63], 0 offen
  v_bfe_u32 v20, v0, 1, 1
  v_mul_u32_u24 v20, 576, v20
  v_add_u32 v16, v16, v20
  v_lshlrev_b32 v141, 1, v16
  buffer_load_ushort v13, v141, s[64:67], 0 offen
  v_mov_b32 v20, 0
  v_mov_b32 v21, 0
  v_lshlrev_b32 v22, 3, v0
  ds_write_b64 v22, v[20:21] offset:2304
  v_and_b32 v20, 7, v0
  v_lshrrev_b32 v21, 1, v20
  v_cmp_eq_u32 vcc, 0, v21
  s_nop 1
  v_cndmask_b32 v64, 0, -1, vcc
  v_cmp_eq_u32 vcc, 1, v21
  s_nop 1
  v_cndmask_b32 v65, 0, -1, vcc
  v_cmp_eq_u32 vcc, 2, v21
  s_nop 1
  v_cndmask_b32 v66, 0, -1, vcc
  v_cmp_eq_u32 vcc, 3, v21
  s_nop 1
  v_cndmask_b32 v67, 0, -1, vcc
  v_and_b32 v68, 1, v0
  v_lshlrev_b32 v68, 4, v68
  v_cmp_gt_u32 s[50:51], 32, v0
  v_bfe_u32 v20, v0, 3, 1
  v_mul_u32_u24 v20, 1152, v20
  v_lshrrev_b32 v21, 4, v0
  v_lshlrev_b32 v21, 1, v21
  v_add_u32 v20, v20, v21
  s_mul_i32 s49, s9, 144
  s_add_u32 s49, s49, 0
  v_add_u32 v16, s49, v20
  v_bfe_u32 v28, v0, 3, 1
  v_lshlrev_b32 v28, 9, v28
  v_lshrrev_b32 v29, 4, v0
  v_lshlrev_b32 v29, 3, v29
  v_and_b32 v30, 7, v0
  v_add_u32 v29, v29, v30
  v_lshlrev_b32 v29, 4, v29
  v_add_u32 v28, v28, v29
  s_lshl_b32 s49, s7, 3
  s_add_u32 s49, s49, s9
  s_lshl_b32 s49, s49, 10
  s_add_u32 s49, s49, 65536
  v_add_u32 v17, s49, v28
  s_lshl_b32 s49, s7, 13
  s_lshl_b32 s48, s6, 9
  s_add_u32 s49, s49, s48
  s_add_u32 s49, s49, 65536
  v_lshrrev_b32 v28, 5, v0
  v_lshlrev_b32 v28, 10, v28
  v_and_b32 v29, 31, v0
  v_lshlrev_b32 v29, 4, v29
  v_add_u32 v28, v28, v29
  v_add_u32 v142, s49, v28
  v_add_u32 v143, 4096, v142
  s_waitcnt vmcnt(22)
  v_lshlrev_b32 v44, 16, v1
  v_and_b32 v53, 0xffff0000, v1
  v_lshlrev_b32 v45, 16, v2
  v_and_b32 v54, 0xffff0000, v2
  v_lshlrev_b32 v46, 16, v3
  v_and_b32 v55, 0xffff0000, v3
  v_lshlrev_b32 v47, 16, v4
  v_and_b32 v56, 0xffff0000, v4
  v_lshlrev_b32 v48, 16, v5
  v_and_b32 v57, 0xffff0000, v5
  v_lshlrev_b32 v49, 16, v6
  v_and_b32 v58, 0xffff0000, v6
  v_lshlrev_b32 v50, 16, v7
  v_and_b32 v59, 0xffff0000, v7
  v_lshlrev_b32 v51, 16, v8
  v_and_b32 v60, 0xffff0000, v8
  v_lshlrev_b32 v52, 16, v9
  v_and_b32 v61, 0xffff0000, v9
  v_add_f32 v20, v44, v53
  v_add_f32 v21, v49, v58
  v_add_f32 v22, v48, v57
  v_add_f32 v23, v45, v54
  v_add_f32 v24, v50, v59
  v_add_f32 v20, v20, v23
  v_add_f32 v21, v21, v24
  v_add_f32 v23, v46, v55
  v_add_f32 v24, v51, v60
  v_add_f32 v20, v20, v23
  v_add_f32 v21, v21, v24
  v_add_f32 v23, v47, v56
  v_add_f32 v24, v52, v61
  v_add_f32 v20, v20, v23
  v_add_f32 v21, v21, v24
  v_cndmask_b32 v23, 0, v22, s[50:51]
  v_cndmask_b32 v24, v22, 0, s[50:51]
  v_add_f32 v20, v20, v23
  v_add_f32 v21, v21, v24
  s_nop 0
  s_nop 0
  v_add_f32_dpp v20, v20, v20 row_ror:8 row_mask:0xf bank_mask:0xf
  v_add_f32_dpp v21, v21, v21 row_ror:8 row_mask:0xf bank_mask:0xf
  s_nop 0
  v_add_f32_dpp v20, v20, v20 row_ror:4 row_mask:0xf bank_mask:0xf
  v_add_f32_dpp v21, v21, v21 row_ror:4 row_mask:0xf bank_mask:0xf
  s_nop 0
  v_add_f32_dpp v20, v20, v20 row_ror:2 row_mask:0xf bank_mask:0xf
  v_add_f32_dpp v21, v21, v21 row_ror:2 row_mask:0xf bank_mask:0xf
  s_nop 0
  v_add_f32_dpp v20, v20, v20 row_ror:1 row_mask:0xf bank_mask:0xf
  v_add_f32_dpp v21, v21, v21 row_ror:1 row_mask:0xf bank_mask:0xf
  s_nop 0
  v_mov_b32 v23, v20
  v_mov_b32 v24, v21
  s_nop 0
  v_permlane16_swap_b32 v20, v23
  v_permlane16_swap_b32 v21, v24
  v_add_f32 v20, v20, v23
  v_add_f32 v21, v21, v24
  v_mov_b32 v23, v20
  v_mov_b32 v24, v21
  s_nop 0
  v_permlane32_swap_b32 v20, v23
  v_permlane32_swap_b32 v21, v24
  v_add_f32 v20, v20, v23
  v_add_f32 v21, v21, v24
  v_mov_b32 v30, 0x3ae38e39
  v_mul_f32 v20, v20, v30
  v_mul_f32 v21, v21, v30
  v_cndmask_b32 v25, v21, v20, s[50:51]
  v_sub_f32 v29, v44, v20
  v_sub_f32 v31, v53, v20
  v_mul_f32 v26, v29, v29
  v_fmac_f32 v26, v31, v31
  v_sub_f32 v29, v49, v21
  v_sub_f32 v31, v58, v21
  v_mul_f32 v27, v29, v29
  v_fmac_f32 v27, v31, v31
  v_sub_f32 v29, v48, v25
  v_sub_f32 v31, v57, v25
  v_mul_f32 v28, v29, v29
  v_fmac_f32 v28, v31, v31
  v_sub_f32 v29, v45, v20
  v_sub_f32 v31, v54, v20
  v_fmac_f32 v26, v29, v29
  v_fmac_f32 v26, v31, v31
  v_sub_f32 v29, v50, v21
  v_sub_f32 v31, v59, v21
  v_fmac_f32 v27, v29, v29
  v_fmac_f32 v27, v31, v31
  v_sub_f32 v29, v46, v20
  v_sub_f32 v31, v55, v20
  v_fmac_f32 v26, v29, v29
  v_fmac_f32 v26, v31, v31
  v_sub_f32 v29, v51, v21
  v_sub_f32 v31, v60, v21
  v_fmac_f32 v27, v29, v29
  v_fmac_f32 v27, v31, v31
  v_sub_f32 v29, v47, v20
  v_sub_f32 v31, v56, v20
  v_fmac_f32 v26, v29, v29
  v_fmac_f32 v26, v31, v31
  v_sub_f32 v29, v52, v21
  v_sub_f32 v31, v61, v21
  v_fmac_f32 v27, v29, v29
  v_fmac_f32 v27, v31, v31
  v_cndmask_b32 v23, 0, v28, s[50:51]
  v_cndmask_b32 v24, v28, 0, s[50:51]
  v_add_f32 v26, v26, v23
  v_add_f32 v27, v27, v24
  s_nop 0
  s_nop 0
  v_add_f32_dpp v26, v26, v26 row_ror:8 row_mask:0xf bank_mask:0xf
  v_add_f32_dpp v27, v27, v27 row_ror:8 row_mask:0xf bank_mask:0xf
  s_nop 0
  v_add_f32_dpp v26, v26, v26 row_ror:4 row_mask:0xf bank_mask:0xf
  v_add_f32_dpp v27, v27, v27 row_ror:4 row_mask:0xf bank_mask:0xf
  s_nop 0
  v_add_f32_dpp v26, v26, v26 row_ror:2 row_mask:0xf bank_mask:0xf
  v_add_f32_dpp v27, v27, v27 row_ror:2 row_mask:0xf bank_mask:0xf
  s_nop 0
  v_add_f32_dpp v26, v26, v26 row_ror:1 row_mask:0xf bank_mask:0xf
  v_add_f32_dpp v27, v27, v27 row_ror:1 row_mask:0xf bank_mask:0xf
  s_nop 0
  v_mov_b32 v23, v26
  v_mov_b32 v24, v27
  s_nop 0
  v_permlane16_swap_b32 v26, v23
  v_permlane16_swap_b32 v27, v24
  v_add_f32 v26, v26, v23
  v_add_f32 v27, v27, v24
  v_mov_b32 v23, v26
  v_mov_b32 v24, v27
  s_nop 0
  v_permlane32_swap_b32 v26, v23
  v_permlane32_swap_b32 v27, v24
  v_add_f32 v26, v26, v23
  v_add_f32 v27, v27, v24
  v_mul_f32 v26, v26, v30
  v_mul_f32 v27, v27, v30
  v_mov_b32 v24, 0x3727c5ac
  v_cvt_pk_bf16_f32 v20, v20, v20
  v_cvt_pk_bf16_f32 v21, v21, v21
  v_cvt_pk_bf16_f32 v26, v26, v26
  v_cvt_pk_bf16_f32 v27, v27, v27
  v_and_b32 v20, 0xffff0000, v20
  v_and_b32 v21, 0xffff0000, v21
  v_and_b32 v26, 0xffff0000, v26
  v_and_b32 v27, 0xffff0000, v27
  v_add_f32 v26, v26, v24
  v_add_f32 v27, v27, v24
  v_cvt_pk_bf16_f32 v26, v26, v26
  v_cvt_pk_bf16_f32 v27, v27, v27
  v_and_b32 v26, 0xffff0000, v26
  v_and_b32 v27, 0xffff0000, v27
  v_sqrt_f32 v26, v26
  v_sqrt_f32 v27, v27
  s_nop 0
  v_cvt_pk_bf16_f32 v26, v26, v26
  v_cvt_pk_bf16_f32 v27, v27, v27
  v_and_b32 v26, 0xffff0000, v26
  v_and_b32 v27, 0xffff0000, v27
  v_rcp_f32 v26, v26
  v_rcp_f32 v27, v27
  v_cndmask_b32 v25, v21, v20, s[50:51]
  v_cndmask_b32 v28, v27, v26, s[50:51]
  v_sub_f32 v44, v44, v20
  v_sub_f32 v53, v53, v20
  v_cvt_pk_bf16_f32 v29, v44, v53
  v_lshlrev_b32 v44, 16, v29
  v_and_b32 v53, 0xffff0000, v29
  v_mul_f32 v44, v44, v26
  v_mul_f32 v53, v53, v26
  v_cvt_pk_bf16_f32 v1, v44, v53
  ds_write_b32 v14, v1 offset:0
  v_sub_f32 v45, v45, v20
  v_sub_f32 v54, v54, v20
  v_cvt_pk_bf16_f32 v29, v45, v54
  v_lshlrev_b32 v45, 16, v29
  v_and_b32 v54, 0xffff0000, v29
  v_mul_f32 v45, v45, v26
  v_mul_f32 v54, v54, v26
  v_cvt_pk_bf16_f32 v2, v45, v54
  ds_write_b32 v14, v2 offset:256
  v_sub_f32 v46, v46, v20
  v_sub_f32 v55, v55, v20
  v_cvt_pk_bf16_f32 v29, v46, v55
  v_lshlrev_b32 v46, 16, v29
  v_and_b32 v55, 0xffff0000, v29
  v_mul_f32 v46, v46, v26
  v_mul_f32 v55, v55, v26
  v_cvt_pk_bf16_f32 v3, v46, v55
  ds_write_b32 v14, v3 offset:512
  v_sub_f32 v47, v47, v20
  v_sub_f32 v56, v56, v20
  v_cvt_pk_bf16_f32 v29, v47, v56
  v_lshlrev_b32 v47, 16, v29
  v_and_b32 v56, 0xffff0000, v29
  v_mul_f32 v47, v47, v26
  v_mul_f32 v56, v56, v26
  v_cvt_pk_bf16_f32 v4, v47, v56
  ds_write_b32 v14, v4 offset:768
  v_sub_f32 v48, v48, v25
  v_sub_f32 v57, v57, v25
  v_cvt_pk_bf16_f32 v29, v48, v57
  v_lshlrev_b32 v48, 16, v29
  v_and_b32 v57, 0xffff0000, v29
  v_mul_f32 v48, v48, v28
  v_mul_f32 v57, v57, v28
  v_cvt_pk_bf16_f32 v5, v48, v57
  ds_write_b32 v14, v5 offset:1024
  v_sub_f32 v49, v49, v21
  v_sub_f32 v58, v58, v21
  v_cvt_pk_bf16_f32 v29, v49, v58
  v_lshlrev_b32 v49, 16, v29
  v_and_b32 v58, 0xffff0000, v29
  v_mul_f32 v49, v49, v27
  v_mul_f32 v58, v58, v27
  v_cvt_pk_bf16_f32 v6, v49, v58
  ds_write_b32 v14, v6 offset:1280
  v_sub_f32 v50, v50, v21
  v_sub_f32 v59, v59, v21
  v_cvt_pk_bf16_f32 v29, v50, v59
  v_lshlrev_b32 v50, 16, v29
  v_and_b32 v59, 0xffff0000, v29
  v_mul_f32 v50, v50, v27
  v_mul_f32 v59, v59, v27
  v_cvt_pk_bf16_f32 v7, v50, v59
  ds_write_b32 v14, v7 offset:1536
  v_sub_f32 v51, v51, v21
  v_sub_f32 v60, v60, v21
  v_cvt_pk_bf16_f32 v29, v51, v60
  v_lshlrev_b32 v51, 16, v29
  v_and_b32 v60, 0xffff0000, v29
  v_mul_f32 v51, v51, v27
  v_mul_f32 v60, v60, v27
  v_cvt_pk_bf16_f32 v8, v51, v60
  ds_write_b32 v14, v8 offset:1792
  v_sub_f32 v52, v52, v21
  v_sub_f32 v61, v61, v21
  v_cvt_pk_bf16_f32 v29, v52, v61
  v_lshlrev_b32 v52, 16, v29
  v_and_b32 v61, 0xffff0000, v29
  v_mul_f32 v52, v52, v27
  v_mul_f32 v61, v61, v27
  v_cvt_pk_bf16_f32 v9, v52, v61
  ds_write_b32 v14, v9 offset:2048
  s_waitcnt lgkmcnt(0)
  ds_read_u16 v76, v16 offset:0
  ds_read_u16 v77, v16 offset:8
  ds_read_u16 v78, v16 offset:16
  ds_read_u16 v79, v16 offset:24
  ds_read_u16 v80, v16 offset:32
  ds_read_u16 v81, v16 offset:40
  ds_read_u16 v82, v16 offset:48
  ds_read_u16 v83, v16 offset:56
  ds_read_u16 v84, v16 offset:64
  ds_read_u16 v85, v16 offset:72
  ds_read_u16 v86, v16 offset:80
  ds_read_u16 v87, v16 offset:88
  ds_read_u16 v88, v16 offset:96
  ds_read_u16 v89, v16 offset:104
  ds_read_u16 v90, v16 offset:112
  ds_read_u16 v91, v16 offset:120
  ds_read_u16 v92, v16 offset:128
  ds_read_u16 v93, v16 offset:136
  s_waitcnt vmcnt(21)
  v_add_u32 v10, 1, v10
  v_mov_b32 v20, 3328
  ds_write_b32 v20, v10
  s_waitcnt lgkmcnt(1)
  v_lshlrev_b32 v76, v68, v76
  v_lshlrev_b32 v77, v68, v77
  v_lshlrev_b32 v78, v68, v78
  v_lshlrev_b32 v79, v68, v79
  v_lshlrev_b32 v80, v68, v80
  v_lshlrev_b32 v81, v68, v81
  v_lshlrev_b32 v82, v68, v82
  v_lshlrev_b32 v83, v68, v83
  v_lshlrev_b32 v84, v68, v84
  v_lshlrev_b32 v85, v68, v85
  v_lshlrev_b32 v86, v68, v86
  v_lshlrev_b32 v87, v68, v87
  v_lshlrev_b32 v88, v68, v88
  v_lshlrev_b32 v89, v68, v89
  v_lshlrev_b32 v90, v68, v90
  v_lshlrev_b32 v91, v68, v91
  v_lshlrev_b32 v92, v68, v92
  v_lshlrev_b32 v93, v68, v93
  v_and_b32 v100, v64, v76
  v_and_b32 v101, v65, v76
  v_and_b32 v102, v66, v76
  v_and_b32 v103, v67, v76
  s_waitcnt vmcnt(20)
  s_nop 0
  v_mfma_f32_16x16x32_bf16 v[72:75], v[152:155], v[100:103], 0
  v_and_b32 v104, v64, v77
  v_and_b32 v105, v65, v77
  v_and_b32 v106, v66, v77
  v_and_b32 v107, v67, v77
  s_waitcnt vmcnt(19)
  s_nop 0
  v_mfma_f32_16x16x32_bf16 v[72:75], v[156:159], v[104:107], v[72:75]
  v_and_b32 v108, v64, v78
  v_and_b32 v109, v65, v78
  v_and_b32 v110, v66, v78
  v_and_b32 v111, v67, v78
  s_waitcnt vmcnt(18)
  s_nop 0
  v_mfma_f32_16x16x32_bf16 v[72:75], v[160:163], v[108:111], v[72:75]
  v_and_b32 v112, v64, v79
  v_and_b32 v113, v65, v79
  v_and_b32 v114, v66, v79
  v_and_b32 v115, v67, v79
  s_waitcnt vmcnt(17)
  s_nop 0
  v_mfma_f32_16x16x32_bf16 v[72:75], v[164:167], v[112:115], v[72:75]
  v_and_b32 v100, v64, v80
  v_and_b32 v101, v65, v80
  v_and_b32 v102, v66, v80
  v_and_b32 v103, v67, v80
  s_waitcnt vmcnt(16)
  s_nop 0
  v_mfma_f32_16x16x32_bf16 v[72:75], v[168:171], v[100:103], v[72:75]
  v_and_b32 v104, v64, v81
  v_and_b32 v105, v65, v81
  v_and_b32 v106, v66, v81
  v_and_b32 v107, v67, v81
  s_waitcnt vmcnt(15)
  s_nop 0
  v_mfma_f32_16x16x32_bf16 v[72:75], v[172:175], v[104:107], v[72:75]
  v_and_b32 v108, v64, v82
  v_and_b32 v109, v65, v82
  v_and_b32 v110, v66, v82
  v_and_b32 v111, v67, v82
  s_waitcnt vmcnt(14)
  s_nop 0
  v_mfma_f32_16x16x32_bf16 v[72:75], v[176:179], v[108:111], v[72:75]
  v_and_b32 v112, v64, v83
  v_and_b32 v113, v65, v83
  v_and_b32 v114, v66, v83
  v_and_b32 v115, v67, v83
  s_waitcnt vmcnt(13)
  s_nop 0
  v_mfma_f32_16x16x32_bf16 v[72:75], v[180:183], v[112:115], v[72:75]
  v_and_b32 v100, v64, v84
  v_and_b32 v101, v65, v84
  v_and_b32 v102, v66, v84
  v_and_b32 v103, v67, v84
  s_waitcnt vmcnt(12)
  s_nop 0
  v_mfma_f32_16x16x32_bf16 v[72:75], v[184:187], v[100:103], v[72:75]
  v_and_b32 v104, v64, v85
  v_and_b32 v105, v65, v85
  v_and_b32 v106, v66, v85
  v_and_b32 v107, v67, v85
  s_waitcnt vmcnt(11)
  s_nop 0
  v_mfma_f32_16x16x32_bf16 v[72:75], v[188:191], v[104:107], v[72:75]
  v_and_b32 v108, v64, v86
  v_and_b32 v109, v65, v86
  v_and_b32 v110, v66, v86
  v_and_b32 v111, v67, v86
  s_waitcnt vmcnt(10)
  s_nop 0
  v_mfma_f32_16x16x32_bf16 v[72:75], v[192:195], v[108:111], v[72:75]
  v_and_b32 v112, v64, v87
  v_and_b32 v113, v65, v87
  v_and_b32 v114, v66, v87
  v_and_b32 v115, v67, v87
  s_waitcnt vmcnt(9)
  s_nop 0
  v_mfma_f32_16x16x32_bf16 v[72:75], v[196:199], v[112:115], v[72:75]
  v_and_b32 v100, v64, v88
  v_and_b32 v101, v65, v88
  v_and_b32 v102, v66, v88
  v_and_b32 v103, v67, v88
  s_waitcnt vmcnt(8)
  s_nop 0
  v_mfma_f32_16x16x32_bf16 v[72:75], v[200:203], v[100:103], v[72:75]
  v_and_b32 v104, v64, v89
  v_and_b32 v105, v65, v89
  v_and_b32 v106, v66, v89
  v_and_b32 v107, v67, v89
  s_waitcnt vmcnt(7)
  s_nop 0
  v_mfma_f32_16x16x32_bf16 v[72:75], v[204:207], v[104:107], v[72:75]
  v_and_b32 v108, v64, v90
  v_and_b32 v109, v65, v90
  v_and_b32 v110, v66, v90
  v_and_b32 v111, v67, v90
  s_waitcnt vmcnt(6)
  s_nop 0
  v_mfma_f32_16x16x32_bf16 v[72:75], v[208:211], v[108:111], v[72:75]
  v_and_b32 v112, v64, v91
  v_and_b32 v113, v65, v91
  v_and_b32 v114, v66, v91
  v_and_b32 v115, v67, v91
  s_waitcnt vmcnt(5)
  s_nop 0
  v_mfma_f32_16x16x32_bf16 v[72:75], v[212:215], v[112:115], v[72:75]
  v_and_b32 v100, v64, v92
  v_and_b32 v101, v65, v92
  v_and_b32 v102, v66, v92
  v_and_b32 v103, v67, v92
  s_waitcnt vmcnt(4)
  s_nop 0
  v_mfma_f32_16x16x32_bf16 v[72:75], v[216:219], v[100:103], v[72:75]
  v_and_b32 v104, v64, v93
  v_and_b32 v105, v65, v93
  v_and_b32 v106, v66, v93
  v_and_b32 v107, v67, v93
  s_waitcnt vmcnt(3)
  s_nop 0
  v_mfma_f32_16x16x32_bf16 v[72:75], v[220:223], v[104:107], v[72:75]
  s_nop 7
  v_perm_b32 v20, v72, v75, s26
  v_perm_b32 v21, v73, v75, s27
  v_perm_b32 v22, v74, v75, s38
  v_mov_b32 v23, v10
  global_store_dwordx4 v17, v[20:23], s[40:41] sc1
  s_setprio 1
  v_lshrrev_b32 v24, 4, v0
  v_lshlrev_b32 v24, 3, v24
  v_bfe_u32 v25, v0, 2, 2
  v_add_u32 v24, v24, v25
  v_lshlrev_b32 v24, 7, v24
  v_and_b32 v25, 3, v0
  v_lshlrev_b32 v25, 3, v25
  v_add_u32 v14, v24, v25
  v_and_b32 v40, 3, v0
  v_lshlrev_b32 v40, 4, v40
  s_mov_b32 s52, 1600000
L_wl_1:
  ds_read_b32 v41, v40 offset:3356
  s_waitcnt lgkmcnt(0)
  v_cmp_gt_u32 vcc, 2, v41
  s_nop 1
  s_cmp_eq_u64 vcc, 0
  s_cbranch_scc1 L_wld_2
  s_sleep 12
  s_sub_u32 s52, s52, 1
  s_cmp_lg_u32 s52, 0
  s_cbranch_scc1 L_wl_1
L_wld_2:
  s_mov_b64 s[56:57], -1
  s_mov_b64 s[58:59], -1
  s_mov_b64 s[60:61], -1
  s_mov_b64 s[62:63], -1
  s_mov_b32 s52, 200000
L_poll_q_3:
  s_mov_b64 exec, s[56:57]
  s_cbranch_execz L_sk_5
  global_load_dwordx4 v[76:79], v142, s[40:41] offset:0 sc1
L_sk_5:
  s_mov_b64 exec, s[58:59]
  s_cbranch_execz L_sk_6
  global_load_dwordx4 v[80:83], v142, s[40:41] offset:2048 sc1
L_sk_6:
  s_mov_b64 exec, s[60:61]
  s_cbranch_execz L_sk_7
  global_load_dwordx4 v[84:87], v143, s[40:41] offset:0 sc1
L_sk_7:
  s_mov_b64 exec, s[62:63]
  s_cbranch_execz L_sk_8
  global_load_dwordx4 v[88:91], v143, s[40:41] offset:2048 sc1
L_sk_8:
  s_waitcnt vmcnt(0)
  s_mov_b64 s[54:55], 0
  s_mov_b64 exec, s[56:57]
  v_cmp_ne_u32 vcc, v10, v79
  s_nop 0
  s_mov_b64 s[56:57], vcc
  s_or_b64 s[54:55], s[54:55], vcc
  s_mov_b64 exec, s[58:59]
  v_cmp_ne_u32 vcc, v10, v83
  s_nop 0
  s_mov_b64 s[58:59], vcc
  s_or_b64 s[54:55], s[54:55], vcc
  s_mov_b64 exec, s[60:61]
  v_cmp_ne_u32 vcc, v10, v87
  s_nop 0
  s_mov_b64 s[60:61], vcc
  s_or_b64 s[54:55], s[54:55], vcc
  s_mov_b64 exec, s[62:63]
  v_cmp_ne_u32 vcc, v10, v91
  s_nop 0
  s_mov_b64 s[62:63], vcc
  s_or_b64 s[54:55], s[54:55], vcc
  s_mov_b64 exec, -1
  s_cmp_eq_u64 s[54:55], 0
  s_cbranch_scc1 L_done_q_4
  s_sleep 8
  s_sub_u32 s52, s52, 1
  s_cmp_lg_u32 s52, 0
  s_cbranch_scc1 L_poll_q_3
L_done_q_4:
  v_perm_b32 v79, v76, v77, s39
  v_perm_b32 v79, v79, v78, s15
  v_perm_b32 v83, v80, v81, s39
  v_perm_b32 v83, v83, v82, s15
  v_perm_b32 v87, v84, v85, s39
  v_perm_b32 v87, v87, v86, s15
  v_perm_b32 v91, v88, v89, s39
  v_perm_b32 v91, v91, v90, s15
  v_add_f32 v76, v76, v80
  v_add_f32 v84, v84, v88
  v_add_f32 v77, v77, v81
  v_add_f32 v85, v85, v89
  v_add_f32 v78, v78, v82
  v_add_f32 v86, v86, v90
  v_add_f32 v79, v79, v83
  v_add_f32 v87, v87, v91
  v_add_f32 v76, v76, v84
  v_add_f32 v77, v77, v85
  v_add_f32 v78, v78, v86
  v_add_f32 v79, v79, v87
  v_mov_b32 v80, v76
  v_mov_b32 v81, v77
  v_mov_b32 v82, v78
  v_mov_b32 v83, v79
  s_nop 0
  v_permlane32_swap_b32 v76, v80
  v_permlane32_swap_b32 v77, v81
  v_permlane32_swap_b32 v78, v82
  v_permlane32_swap_b32 v79, v83
  v_add_f32 v76, v76, v80
  v_add_f32 v77, v77, v81
  v_add_f32 v78, v78, v82
  v_add_f32 v79, v79, v83
  v_bfe_u32 v20, v0, 3, 2
  v_lshlrev_b32 v20, 5, v20
  v_and_b32 v21, 7, v0
  v_add_u32 v20, v20, v21
  v_lshlrev_b32 v20, 1, v20
  v_cvt_pk_bf16_f32 v21, v76, v77
  v_cvt_pk_bf16_f32 v22, v78, v79
  ds_write_b16 v20, v21 offset:3072
  ds_write_b16_d16_hi v20, v21 offset:3088
  ds_write_b16 v20, v22 offset:3104
  ds_write_b16_d16_hi v20, v22 offset:3120
  s_waitcnt lgkmcnt(0)
  s_barrier
  s_cmp_lg_u32 s13, 1
  s_cbranch_scc1 L_nomlp
  v_and_b32 v40, 3, v0
  v_lshlrev_b32 v40, 4, v40
  s_mov_b32 s52, 1600000
L_wl_9:
  ds_read_b32 v41, v40 offset:3356
  s_waitcnt lgkmcnt(0)
  v_cmp_gt_u32 vcc, 3, v41
  s_nop 1
  s_cmp_eq_u64 vcc, 0
  s_cbranch_scc1 L_wld_10
  s_sleep 12
  s_sub_u32 s52, s52, 1
  s_cmp_lg_u32 s52, 0
  s_cbranch_scc1 L_wl_9
L_wld_10:
  s_mul_i32 s49, s12, 384
  v_and_b32 v20, 3, v0
  v_mul_u32_u24 v21, 1152, v20
  v_add_u32 v21, s49, v21
  v_add_u32 v21, 0, v21
  v_cmp_gt_u32 vcc, 2, v20
  v_mov_b32 v22, 2304
  s_nop 0
  v_cndmask_b32 v21, v22, v21, vcc
  v_lshrrev_b32 v22, 4, v0
  v_lshlrev_b32 v22, 4, v22
  v_add_u32 v15, v21, v22
  ds_read_b128 v[116:119], v15 offset:0
  ds_read_b64_tr_b16 v[100:101], v14 offset:22784
  ds_read_b64_tr_b16 v[102:103], v14 offset:23296
  ds_read_b64_tr_b16 v[104:105], v14 offset:22816
  ds_read_b64_tr_b16 v[106:107], v14 offset:23328
  ds_read_b64_tr_b16 v[108:109], v14 offset:22848
  ds_read_b64_tr_b16 v[110:111], v14 offset:23360
  ds_read_b64_tr_b16 v[112:113], v14 offset:22880
  ds_read_b64_tr_b16 v[114:115], v14 offset:23392
  s_waitcnt lgkmcnt(0)
  v_mfma_f32_16x16x32_bf16 v[124:127], v[116:119], v[100:103], 0
  v_mfma_f32_16x16x32_bf16 v[128:131], v[116:119], v[104:107], 0
  v_mfma_f32_16x16x32_bf16 v[132:135], v[116:119], v[108:111], 0
  v_mfma_f32_16x16x32_bf16 v[136:139], v[116:119], v[112:115], 0
  ds_read_b128 v[120:123], v15 offset:64
  ds_read_b64_tr_b16 v[100:101], v14 offset:26880
  ds_read_b64_tr_b16 v[102:103], v14 offset:27392
  ds_read_b64_tr_b16 v[104:105], v14 offset:26912
  ds_read_b64_tr_b16 v[106:107], v14 offset:27424
  ds_read_b64_tr_b16 v[108:109], v14 offset:26944
  ds_read_b64_tr_b16 v[110:111], v14 offset:27456
  ds_read_b64_tr_b16 v[112:113], v14 offset:26976
  ds_read_b64_tr_b16 v[114:115], v14 offset:27488
  s_waitcnt lgkmcnt(0)
  v_mfma_f32_16x16x32_bf16 v[124:127], v[120:123], v[100:103], v[124:127]
  v_mfma_f32_16x16x32_bf16 v[128:131], v[120:123], v[104:107], v[128:131]
  v_mfma_f32_16x16x32_bf16 v[132:135], v[120:123], v[108:111], v[132:135]
  v_mfma_f32_16x16x32_bf16 v[136:139], v[120:123], v[112:115], v[136:139]
  ds_read_b128 v[116:119], v15 offset:128
  ds_read_b64_tr_b16 v[100:101], v14 offset:30976
  ds_read_b64_tr_b16 v[102:103], v14 offset:31488
  ds_read_b64_tr_b16 v[104:105], v14 offset:31008
  ds_read_b64_tr_b16 v[106:107], v14 offset:31520
  ds_read_b64_tr_b16 v[108:109], v14 offset:31040
  ds_read_b64_tr_b16 v[110:111], v14 offset:31552
  ds_read_b64_tr_b16 v[112:113], v14 offset:31072
  ds_read_b64_tr_b16 v[114:115], v14 offset:31584
  s_waitcnt lgkmcnt(0)
  v_mfma_f32_16x16x32_bf16 v[124:127], v[116:119], v[100:103], v[124:127]
  v_mfma_f32_16x16x32_bf16 v[128:131], v[116:119], v[104:107], v[128:131]
  v_mfma_f32_16x16x32_bf16 v[132:135], v[116:119], v[108:111], v[132:135]
  v_mfma_f32_16x16x32_bf16 v[136:139], v[116:119], v[112:115], v[136:139]
  ds_read_b128 v[120:123], v15 offset:192
  ds_read_b64_tr_b16 v[100:101], v14 offset:35072
  ds_read_b64_tr_b16 v[102:103], v14 offset:35584
  ds_read_b64_tr_b16 v[104:105], v14 offset:35104
  ds_read_b64_tr_b16 v[106:107], v14 offset:35616
  ds_read_b64_tr_b16 v[108:109], v14 offset:35136
  ds_read_b64_tr_b16 v[110:111], v14 offset:35648
  ds_read_b64_tr_b16 v[112:113], v14 offset:35168
  ds_read_b64_tr_b16 v[114:115], v14 offset:35680
  s_waitcnt lgkmcnt(0)
  v_mfma_f32_16x16x32_bf16 v[124:127], v[120:123], v[100:103], v[124:127]
  v_mfma_f32_16x16x32_bf16 v[128:131], v[120:123], v[104:107], v[128:131]
  v_mfma_f32_16x16x32_bf16 v[132:135], v[120:123], v[108:111], v[132:135]
  v_mfma_f32_16x16x32_bf16 v[136:139], v[120:123], v[112:115], v[136:139]
  ds_read_b128 v[116:119], v15 offset:256
  ds_read_b64_tr_b16 v[100:101], v14 offset:39168
  ds_read_b64_tr_b16 v[102:103], v14 offset:39680
  ds_read_b64_tr_b16 v[104:105], v14 offset:39200
  ds_read_b64_tr_b16 v[106:107], v14 offset:39712
  ds_read_b64_tr_b16 v[108:109], v14 offset:39232
  ds_read_b64_tr_b16 v[110:111], v14 offset:39744
  ds_read_b64_tr_b16 v[112:113], v14 offset:39264
  ds_read_b64_tr_b16 v[114:115], v14 offset:39776
  s_waitcnt lgkmcnt(0)
  v_mfma_f32_16x16x32_bf16 v[124:127], v[116:119], v[100:103], v[124:127]
  v_mfma_f32_16x16x32_bf16 v[128:131], v[116:119], v[104:107], v[128:131]
  v_mfma_f32_16x16x32_bf16 v[132:135], v[116:119], v[108:111], v[132:135]
  v_mfma_f32_16x16x32_bf16 v[136:139], v[116:119], v[112:115], v[136:139]
  ds_read_b128 v[120:123], v15 offset:320
  ds_read_b64_tr_b16 v[100:101], v14 offset:43264
  ds_read_b64_tr_b16 v[102:103], v14 offset:43776
  ds_read_b64_tr_b16 v[104:105], v14 offset:43296
  ds_read_b64_tr_b16 v[106:107], v14 offset:43808
  ds_read_b64_tr_b16 v[108:109], v14 offset:43328
  ds_read_b64_tr_b16 v[110:111], v14 offset:43840
  ds_read_b64_tr_b16 v[112:113], v14 offset:43360
  ds_read_b64_tr_b16 v[114:115], v14 offset:43872
  s_waitcnt lgkmcnt(0)
  v_mfma_f32_16x16x32_bf16 v[124:127], v[120:123], v[100:103], v[124:127]
  v_mfma_f32_16x16x32_bf16 v[128:131], v[120:123], v[104:107], v[128:131]
  v_mfma_f32_16x16x32_bf16 v[132:135], v[120:123], v[108:111], v[132:135]
  v_mfma_f32_16x16x32_bf16 v[136:139], v[120:123], v[112:115], v[136:139]
  s_nop 7
  v_lshrrev_b32 v20, 4, v0
  v_mov_b32 v32, v124
  v_mov_b32 v33, v125
  v_cmp_eq_u32 vcc, 1, v20
  s_nop 1
  v_cndmask_b32 v32, v32, v128, vcc
  v_cndmask_b32 v33, v33, v129, vcc
  v_cmp_eq_u32 vcc, 2, v20
  s_nop 1
  v_cndmask_b32 v32, v32, v132, vcc
  v_cndmask_b32 v33, v33, v133, vcc
  v_cmp_eq_u32 vcc, 3, v20
  s_nop 1
  v_cndmask_b32 v32, v32, v136, vcc
  v_cndmask_b32 v33, v33, v137, vcc
  s_nop 1
  v_mov_b32_dpp v34, v32 quad_perm:[1,0,3,2] row_mask:0xf bank_mask:0xf
  v_mov_b32_dpp v35, v33 quad_perm:[1,0,3,2] row_mask:0xf bank_mask:0xf
  v_perm_b32 v36, v32, v35, s26
  v_perm_b32 v37, v33, v35, s27
  v_perm_b32 v38, v34, v35, s38
  v_mov_b32 v39, v10
  v_lshrrev_b32 v16, 1, v0
  v_lshlrev_b32 v16, 4, v16
  s_lshl_b32 s49, s10, 9
  s_add_u32 s49, s49, 393216
  v_add_u32 v17, s49, v16
  s_mov_b32 exec_lo, 0x55555555
  s_mov_b32 exec_hi, 0x55555555
  global_store_dwordx4 v17, v[36:39], s[40:41] sc1
  s_mov_b64 exec, -1
  v_and_b32 v40, 3, v0
  v_lshlrev_b32 v40, 4, v40
  s_mov_b32 s52, 1600000
L_wl_11:
  ds_read_b32 v41, v40 offset:3352
  s_waitcnt lgkmcnt(0)
  v_cmp_gt_u32 vcc, 1, v41
  s_nop 1
  s_cmp_eq_u64 vcc, 0
  s_cbranch_scc1 L_wld_12
  s_sleep 12
  s_sub_u32 s52, s52, 1
  s_cmp_lg_u32 s52, 0
  s_cbranch_scc1 L_wl_11
L_wld_12:
  s_mul_i32 s49, s11, 1536
  s_add_u32 s49, s49, 393216
  v_lshlrev_b32 v17, 4, v0
  v_add_u32 v17, s49, v17
  v_mov_b32 v80, 0
  v_mov_b32 v81, 0
  v_mov_b32 v82, 0
  v_mov_b32 v83, 0
  s_mov_b64 s[56:57], -1
  s_mov_b32 s58, 0xffffffff
  s_mov_b32 s59, 0x0
  s_mov_b32 s52, 200000
L_poll_h_13:
  s_mov_b64 exec, s[56:57]
  s_cbranch_execz L_sk_15
  global_load_dwordx4 v[76:79], v17, s[40:41] offset:0 sc1
L_sk_15:
  s_mov_b64 exec, s[58:59]
  s_cbranch_execz L_sk_16
  global_load_dwordx4 v[80:83], v17, s[40:41] offset:1024 sc1
L_sk_16:
  s_waitcnt vmcnt(0)
  s_mov_b64 s[54:55], 0
  s_mov_b64 exec, s[56:57]
  v_cmp_ne_u32 vcc, v10, v79
  s_nop 0
  s_mov_b64 s[56:57], vcc
  s_or_b64 s[54:55], s[54:55], vcc
  s_mov_b64 exec, s[58:59]
  v_cmp_ne_u32 vcc, v10, v83
  s_nop 0
  s_mov_b64 s[58:59], vcc
  s_or_b64 s[54:55], s[54:55], vcc
  s_mov_b64 exec, -1
  s_cmp_eq_u64 s[54:55], 0
  s_cbranch_scc1 L_done_h_14
  s_sleep 16
  s_sub_u32 s52, s52, 1
  s_cmp_lg_u32 s52, 0
  s_cbranch_scc1 L_poll_h_13
L_done_h_14:
  v_perm_b32 v79, v76, v77, s39
  v_perm_b32 v79, v79, v78, s15
  v_perm_b32 v83, v80, v81, s39
  v_perm_b32 v83, v83, v82, s15
  v_add_f32 v76, v76, v80
  v_add_f32 v77, v77, v81
  v_add_f32 v78, v78, v82
  v_add_f32 v79, v79, v83
  v_mov_b32 v80, v76
  v_mov_b32 v81, v77
  v_mov_b32 v82, v78
  v_mov_b32 v83, v79
  s_nop 0
  v_permlane32_swap_b32 v76, v80
  v_permlane32_swap_b32 v77, v81
  v_permlane32_swap_b32 v78, v82
  v_permlane32_swap_b32 v79, v83
  v_add_f32 v76, v76, v80
  v_add_f32 v77, v77, v81
  v_add_f32 v78, v78, v82
  v_add_f32 v79, v79, v83
  v_lshlrev_b32 v20, 16, v11
  v_and_b32 v21, 0xffff0000, v11
  v_cvt_pk_bf16_f32 v76, v76, v76
  v_cvt_pk_bf16_f32 v77, v77, v77
  v_cvt_pk_bf16_f32 v78, v78, v78
  v_cvt_pk_bf16_f32 v79, v79, v79
  v_and_b32 v76, 0xffff0000, v76
  v_and_b32 v77, 0xffff0000, v77
  v_and_b32 v78, 0xffff0000, v78
  v_and_b32 v79, 0xffff0000, v79
  v_add_f32 v76, v76, v20
  v_add_f32 v77, v77, v20
  v_add_f32 v78, v78, v21
  v_add_f32 v79, v79, v21
  v_cvt_pk_bf16_f32 v76, v76, v76
  v_cvt_pk_bf16_f32 v77, v77, v77
  v_cvt_pk_bf16_f32 v78, v78, v78
  v_cvt_pk_bf16_f32 v79, v79, v79
  v_and_b32 v76, 0xffff0000, v76
  v_and_b32 v77, 0xffff0000, v77
  v_and_b32 v78, 0xffff0000, v78
  v_and_b32 v79, 0xffff0000, v79
  v_max_f32 v76, 0, v76
  v_max_f32 v77, 0, v77
  v_max_f32 v78, 0, v78
  v_max_f32 v79, 0, v79
  v_mul_f32 v76, v76, v76
  v_mul_f32 v77, v77, v77
  v_mul_f32 v78, v78, v78
  v_mul_f32 v79, v79, v79
  v_cvt_pk_bf16_f32 v22, v76, v78
  v_cvt_pk_bf16_f32 v23, v77, v79
  v_and_b32 v24, 31, v0
  v_lshlrev_b32 v24, 2, v24
  ds_write_b32 v24, v22 offset:2816
  ds_write_b32 v24, v23 offset:2944
  s_waitcnt lgkmcnt(0)
L_nomlp:
  v_and_b32 v40, 3, v0
  v_lshlrev_b32 v40, 4, v40
  s_mov_b32 s52, 1600000
L_wl_17:
  ds_read_b32 v41, v40 offset:3352
  s_waitcnt lgkmcnt(0)
  v_cmp_gt_u32 vcc, 1, v41
  s_nop 1
  s_cmp_eq_u64 vcc, 0
  s_cbranch_scc1 L_wld_18
  s_sleep 12
  s_sub_u32 s52, s52, 1
  s_cmp_lg_u32 s52, 0
  s_cbranch_scc1 L_wl_17
L_wld_18:
  v_and_b32 v20, 3, v0
  v_lshlrev_b32 v20, 4, v20
  ds_read_b64 v[144:145], v20 offset:3344
  s_waitcnt lgkmcnt(0)
  s_mov_b32 s53, 0x3fb8aa3b
  v_mov_b32 v24, v144
  s_nop 1
  v_max_f32_dpp v24, v24, v24 quad_perm:[1,0,3,2] row_mask:0xf bank_mask:0xf
  s_nop 1
  v_max_f32_dpp v24, v24, v24 quad_perm:[2,3,0,1] row_mask:0xf bank_mask:0xf
  v_sub_f32 v25, v144, v24
  v_mul_f32 v25, s53, v25
  v_exp_f32 v25, v25
  s_nop 0
  v_mul_f32 v25, v25, v145
  s_nop 1
  v_add_f32_dpp v25, v25, v25 quad_perm:[1,0,3,2] row_mask:0xf bank_mask:0xf
  s_nop 1
  v_add_f32_dpp v25, v25, v25 quad_perm:[2,3,0,1] row_mask:0xf bank_mask:0xf
  v_mov_b32 v26, 0
  v_mov_b32 v27, v10
  s_lshl_b32 s49, s6, 5
  s_add_u32 s49, s49, s7
  s_lshl_b32 s49, s49, 6
  s_add_u32 s49, s49, 917504
  s_lshl_b32 s50, s8, 4
  s_add_u32 s50, s50, s49
  v_mov_b32 v17, s50
  s_mov_b64 exec, 1
  global_store_dwordx4 v17, v[24:27], s[40:41] sc1
  s_mov_b64 exec, -1
  v_add_u32 v17, s49, v20
  v_lshrrev_b32 v20, 1, v0
  v_mul_u32_u24 v20, 4608, v20
  v_and_b32 v21, 1, v0
  v_lshlrev_b32 v21, 4, v21
  v_add_u32 v28, v20, v21
  s_lshl_b32 s49, s2, 5
  s_add_u32 s49, s49, 524288
  v_add_u32 v31, s49, v28
  v_add_u32 v32, 147456, v31
  v_add_u32 v33, 294912, v31
  v_lshlrev_b32 v12, 16, v12
  v_lshlrev_b32 v13, 16, v13
  v_mov_b32 v146, v31
  v_mov_b32 v147, v32
  v_mov_b32 v148, v33
  v_and_b32 v40, 3, v0
  v_lshlrev_b32 v40, 4, v40
  s_mov_b32 s52, 1600000
L_wl_19:
  ds_read_b32 v41, v40 offset:3356
  s_waitcnt lgkmcnt(0)
  v_cmp_gt_u32 vcc, 4, v41
  s_nop 1
  s_cmp_eq_u64 vcc, 0
  s_cbranch_scc1 L_wld_20
  s_sleep 12
  s_sub_u32 s52, s52, 1
  s_cmp_lg_u32 s52, 0
  s_cbranch_scc1 L_wl_19
L_wld_20:
  s_mov_b64 s[56:57], -1
  s_mov_b32 s52, 200000
L_poll_st_21:
  s_mov_b64 exec, s[56:57]
  s_cbranch_execz L_sk_23
  global_load_dwordx4 v[88:91], v17, s[40:41] offset:0 sc1
L_sk_23:
  s_waitcnt vmcnt(0)
  s_mov_b64 s[54:55], 0
  s_mov_b64 exec, s[56:57]
  v_cmp_ne_u32 vcc, v10, v91
  s_nop 0
  s_mov_b64 s[56:57], vcc
  s_or_b64 s[54:55], s[54:55], vcc
  s_mov_b64 exec, -1
  s_cmp_eq_u64 s[54:55], 0
  s_cbranch_scc1 L_done_st_22
  s_sleep 16
  s_sub_u32 s52, s52, 1
  s_cmp_lg_u32 s52, 0
  s_cbranch_scc1 L_poll_st_21
L_done_st_22:
  v_mov_b32 v21, v88
  s_nop 1
  v_max_f32_dpp v21, v21, v21 quad_perm:[1,0,3,2] row_mask:0xf bank_mask:0xf
  s_nop 1
  v_max_f32_dpp v21, v21, v21 quad_perm:[2,3,0,1] row_mask:0xf bank_mask:0xf
  v_sub_f32 v22, v88, v21
  v_mul_f32 v22, s53, v22
  v_exp_f32 v22, v22
  s_nop 0
  v_mul_f32 v22, v22, v89
  s_nop 1
  v_add_f32_dpp v22, v22, v22 quad_perm:[1,0,3,2] row_mask:0xf bank_mask:0xf
  s_nop 1
  v_add_f32_dpp v22, v22, v22 quad_perm:[2,3,0,1] row_mask:0xf bank_mask:0xf
  v_rcp_f32 v22, v22
  v_sub_f32 v23, v144, v21
  v_mul_f32 v23, s53, v23
  v_exp_f32 v23, v23
  s_nop 0
  v_mul_f32 v23, v23, v22
  s_nop 0
  v_readlane_b32 s44, v23, 0
  v_readlane_b32 s45, v23, 1
  v_readlane_b32 s46, v23, 2
  v_readlane_b32 s47, v23, 3
  v_and_b32 v14, 31, v0
  v_lshlrev_b32 v14, 4, v14
  s_lshl_b32 s49, s7, 12
  s_add_u32 s49, s49, 983040
  s_lshl_b32 s50, s9, 9
  s_add_u32 s50, s50, s49
  v_add_u32 v15, s50, v14
  v_lshlrev_b32 v16, 4, v0
  v_add_u32 v16, s49, v16
  s_lshl_b32 s49, s2, 5
  s_add_u32 s49, s49, 1179648
  v_add_u32 v17, s49, v28
  v_lshrrev_b32 v42, 5, v0
  v_lshlrev_b32 v42, 8, v42
  v_and_b32 v43, 31, v0
  v_lshlrev_b32 v43, 3, v43
  v_add_u32 v42, v42, v43
  s_mov_b64 s[56:57], -1
  s_mov_b64 s[58:59], -1
  s_mov_b64 s[60:61], -1
  s_mov_b64 s[62:63], -1
  s_setprio 3
  s_barrier
  ds_read_b128 v[20:23], v14 offset:3600
  ds_read_b128 v[24:27], v14 offset:4112
  ds_read_b128 v[28:31], v14 offset:4624
  ds_read_b128 v[32:35], v14 offset:5136
  s_waitcnt lgkmcnt(3)
  v_mul_f32 v92, s44, v20
  v_mul_f32 v93, s44, v21
  v_mul_f32 v94, s44, v22
  v_mul_f32 v95, s44, v23
  s_waitcnt lgkmcnt(2)
  v_fmac_f32 v92, s45, v24
  v_fmac_f32 v93, s45, v25
  v_fmac_f32 v94, s45, v26
  v_fmac_f32 v95, s45, v27
  s_waitcnt lgkmcnt(1)
  v_fmac_f32 v92, s46, v28
  v_fmac_f32 v93, s46, v29
  v_fmac_f32 v94, s46, v30
  v_fmac_f32 v95, s46, v31
  s_waitcnt lgkmcnt(0)
  v_fmac_f32 v92, s47, v32
  v_fmac_f32 v93, s47, v33
  v_fmac_f32 v94, s47, v34
  v_fmac_f32 v95, s47, v35
  v_perm_b32 v36, v92, v95, s26
  v_perm_b32 v37, v93, v95, s27
  v_perm_b32 v38, v94, v95, s38
  v_mov_b32 v39, v10
  s_mov_b32 exec_lo, 0xffffffff
  s_mov_b32 exec_hi, 0x0
  global_store_dwordx4 v15, v[36:39], s[40:41] sc1
  s_mov_b64 s[56:57], -1
  s_mov_b64 s[58:59], -1
  s_mov_b64 s[60:61], -1
  s_mov_b64 s[62:63], -1
  s_cmp_eq_u64 s[56:57], 0
  s_cselect_b64 exec, 1, s[56:57]
  global_load_dwordx4 v[152:155], v16, s[40:41] offset:0 sc1
  s_cmp_eq_u64 s[58:59], 0
  s_cselect_b64 exec, 1, s[58:59]
  global_load_dwordx4 v[156:159], v16, s[40:41] offset:1024 sc1
  s_cmp_eq_u64 s[60:61], 0
  s_cselect_b64 exec, 1, s[60:61]
  global_load_dwordx4 v[160:163], v16, s[40:41] offset:2048 sc1
  s_cmp_eq_u64 s[62:63], 0
  s_cselect_b64 exec, 1, s[62:63]
  global_load_dwordx4 v[164:167], v16, s[40:41] offset:3072 sc1
  s_sleep 8
  s_cmp_eq_u64 s[56:57], 0
  s_cselect_b64 exec, 1, s[56:57]
  global_load_dwordx4 v[168:171], v16, s[40:41] offset:0 sc1
  s_cmp_eq_u64 s[58:59], 0
  s_cselect_b64 exec, 1, s[58:59]
  global_load_dwordx4 v[172:175], v16, s[40:41] offset:1024 sc1
  s_cmp_eq_u64 s[60:61], 0
  s_cselect_b64 exec, 1, s[60:61]
  global_load_dwordx4 v[176:179], v16, s[40:41] offset:2048 sc1
  s_cmp_eq_u64 s[62:63], 0
  s_cselect_b64 exec, 1, s[62:63]
  global_load_dwordx4 v[180:183], v16, s[40:41] offset:3072 sc1
  s_mov_b32 s52, 200000
L_pp_op_24:
  s_waitcnt vmcnt(4)
  s_mov_b64 s[54:55], 0
  s_mov_b64 exec, s[56:57]
  v_cmp_eq_u32 vcc, v10, v155
  s_nop 0
  s_andn2_b64 s[56:57], s[56:57], vcc
  s_mov_b64 exec, vcc
  v_mov_b32 v76, v152
  v_mov_b32 v77, v153
  v_mov_b32 v78, v154
  s_or_b64 s[54:55], s[54:55], s[56:57]
  s_mov_b64 exec, s[58:59]
  v_cmp_eq_u32 vcc, v10, v159
  s_nop 0
  s_andn2_b64 s[58:59], s[58:59], vcc
  s_mov_b64 exec, vcc
  v_mov_b32 v80, v156
  v_mov_b32 v81, v157
  v_mov_b32 v82, v158
  s_or_b64 s[54:55], s[54:55], s[58:59]
  s_mov_b64 exec, s[60:61]
  v_cmp_eq_u32 vcc, v10, v163
  s_nop 0
  s_andn2_b64 s[60:61], s[60:61], vcc
  s_mov_b64 exec, vcc
  v_mov_b32 v84, v160
  v_mov_b32 v85, v161
  v_mov_b32 v86, v162
  s_or_b64 s[54:55], s[54:55], s[60:61]
  s_mov_b64 exec, s[62:63]
  v_cmp_eq_u32 vcc, v10, v167
  s_nop 0
  s_andn2_b64 s[62:63], s[62:63], vcc
  s_mov_b64 exec, vcc
  v_mov_b32 v88, v164
  v_mov_b32 v89, v165
  v_mov_b32 v90, v166
  s_or_b64 s[54:55], s[54:55], s[62:63]
  s_cmp_eq_u64 s[54:55], 0
  s_cbranch_scc1 L_ppd_op_25
  s_cmp_eq_u64 s[56:57], 0
  s_cselect_b64 exec, 1, s[56:57]
  global_load_dwordx4 v[152:155], v16, s[40:41] offset:0 sc1
  s_cmp_eq_u64 s[58:59], 0
  s_cselect_b64 exec, 1, s[58:59]
  global_load_dwordx4 v[156:159], v16, s[40:41] offset:1024 sc1
  s_cmp_eq_u64 s[60:61], 0
  s_cselect_b64 exec, 1, s[60:61]
  global_load_dwordx4 v[160:163], v16, s[40:41] offset:2048 sc1
  s_cmp_eq_u64 s[62:63], 0
  s_cselect_b64 exec, 1, s[62:63]
  global_load_dwordx4 v[164:167], v16, s[40:41] offset:3072 sc1
  s_waitcnt vmcnt(4)
  s_mov_b64 s[54:55], 0
  s_mov_b64 exec, s[56:57]
  v_cmp_eq_u32 vcc, v10, v171
  s_nop 0
  s_andn2_b64 s[56:57], s[56:57], vcc
  s_mov_b64 exec, vcc
  v_mov_b32 v76, v168
  v_mov_b32 v77, v169
  v_mov_b32 v78, v170
  s_or_b64 s[54:55], s[54:55], s[56:57]
  s_mov_b64 exec, s[58:59]
  v_cmp_eq_u32 vcc, v10, v175
  s_nop 0
  s_andn2_b64 s[58:59], s[58:59], vcc
  s_mov_b64 exec, vcc
  v_mov_b32 v80, v172
  v_mov_b32 v81, v173
  v_mov_b32 v82, v174
  s_or_b64 s[54:55], s[54:55], s[58:59]
  s_mov_b64 exec, s[60:61]
  v_cmp_eq_u32 vcc, v10, v179
  s_nop 0
  s_andn2_b64 s[60:61], s[60:61], vcc
  s_mov_b64 exec, vcc
  v_mov_b32 v84, v176
  v_mov_b32 v85, v177
  v_mov_b32 v86, v178
  s_or_b64 s[54:55], s[54:55], s[60:61]
  s_mov_b64 exec, s[62:63]
  v_cmp_eq_u32 vcc, v10, v183
  s_nop 0
  s_andn2_b64 s[62:63], s[62:63], vcc
  s_mov_b64 exec, vcc
  v_mov_b32 v88, v180
  v_mov_b32 v89, v181
  v_mov_b32 v90, v182
  s_or_b64 s[54:55], s[54:55], s[62:63]
  s_cmp_eq_u64 s[54:55], 0
  s_cbranch_scc1 L_ppd_op_25
  s_cmp_eq_u64 s[56:57], 0
  s_cselect_b64 exec, 1, s[56:57]
  global_load_dwordx4 v[168:171], v16, s[40:41] offset:0 sc1
  s_cmp_eq_u64 s[58:59], 0
  s_cselect_b64 exec, 1, s[58:59]
  global_load_dwordx4 v[172:175], v16, s[40:41] offset:1024 sc1
  s_cmp_eq_u64 s[60:61], 0
  s_cselect_b64 exec, 1, s[60:61]
  global_load_dwordx4 v[176:179], v16, s[40:41] offset:2048 sc1
  s_cmp_eq_u64 s[62:63], 0
  s_cselect_b64 exec, 1, s[62:63]
  global_load_dwordx4 v[180:183], v16, s[40:41] offset:3072 sc1
  s_sub_u32 s52, s52, 1
  s_cmp_lg_u32 s52, 0
  s_cbranch_scc1 L_pp_op_24
L_ppd_op_25:
  s_mov_b64 exec, -1
  v_perm_b32 v79, v76, v77, s39
  v_perm_b32 v79, v79, v78, s15
  v_perm_b32 v83, v80, v81, s39
  v_perm_b32 v83, v83, v82, s15
  v_perm_b32 v87, v84, v85, s39
  v_perm_b32 v87, v87, v86, s15
  v_perm_b32 v91, v88, v89, s39
  v_perm_b32 v91, v91, v90, s15
  v_add_f32 v76, v76, v80
  v_add_f32 v84, v84, v88
  v_add_f32 v77, v77, v81
  v_add_f32 v85, v85, v89
  v_add_f32 v78, v78, v82
  v_add_f32 v86, v86, v90
  v_add_f32 v79, v79, v83
  v_add_f32 v87, v87, v91
  s_nop 0
  v_permlane32_swap_b32 v76, v84
  v_permlane32_swap_b32 v77, v85
  v_permlane32_swap_b32 v78, v86
  v_permlane32_swap_b32 v79, v87
  v_add_f32 v76, v76, v84
  v_add_f32 v77, v77, v85
  v_add_f32 v78, v78, v86
  v_add_f32 v79, v79, v87
  v_cvt_pk_bf16_f32 v20, v76, v77
  v_cvt_pk_bf16_f32 v21, v78, v79
  ds_write_b64 v42, v[20:21] offset:5648
  s_waitcnt lgkmcnt(0)
  s_barrier
  s_cmp_ge_u32 s2, 144
  s_cbranch_scc1 L_fin
  s_mov_b32 s44, s36
  s_mov_b32 s45, s37
  s_mov_b32 s46, 2304
  s_mov_b32 s47, 0x00020000
  v_and_b32 v28, 2, v0
  v_cmp_ne_u32 s[48:49], 0, v28
  v_and_b32 v28, 4, v0
  v_cmp_ne_u32 s[50:51], 0, v28
  v_mov_b32 v84, 0
  v_mov_b32 v85, 0
  v_mov_b32 v86, 0
  s_mov_b64 s[56:57], -1
  s_mov_b64 s[58:59], -1
  s_mov_b32 s60, 0xffff
  s_mov_b32 s61, 0
  s_mov_b64 s[62:63], -1
  s_mov_b32 s66, 0
  s_cmp_eq_u64 s[56:57], 0
  s_cselect_b64 exec, 1, s[56:57]
  global_load_dwordx4 v[152:155], v146, s[40:41] offset:0 sc1
  s_cmp_eq_u64 s[58:59], 0
  s_cselect_b64 exec, 1, s[58:59]
  global_load_dwordx4 v[156:159], v147, s[40:41] offset:0 sc1
  s_cmp_eq_u64 s[60:61], 0
  s_cselect_b64 exec, 1, s[60:61]
  global_load_dwordx4 v[160:163], v148, s[40:41] offset:0 sc1
  s_cmp_eq_u64 s[62:63], 0
  s_cselect_b64 exec, 1, s[62:63]
  global_load_dwordx4 v[164:167], v17, s[40:41] offset:0 sc1
  s_sleep 8
  s_cmp_eq_u64 s[56:57], 0
  s_cselect_b64 exec, 1, s[56:57]
  global_load_dwordx4 v[168:171], v146, s[40:41] offset:0 sc1
  s_cmp_eq_u64 s[58:59], 0
  s_cselect_b64 exec, 1, s[58:59]
  global_load_dwordx4 v[172:175], v147, s[40:41] offset:0 sc1
  s_cmp_eq_u64 s[60:61], 0
  s_cselect_b64 exec, 1, s[60:61]
  global_load_dwordx4 v[176:179], v148, s[40:41] offset:0 sc1
  s_cmp_eq_u64 s[62:63], 0
  s_cselect_b64 exec, 1, s[62:63]
  global_load_dwordx4 v[180:183], v17, s[40:41] offset:0 sc1
  s_mov_b32 s52, 200000
L_fp_26:
  s_waitcnt vmcnt(4)
  s_mov_b64 exec, s[62:63]
  v_cmp_eq_u32 vcc, v10, v167
  s_nop 0
  s_andn2_b64 s[62:63], s[62:63], vcc
  s_mov_b64 exec, vcc
  v_mov_b32 v92, v164
  v_mov_b32 v93, v165
  v_mov_b32 v94, v166
  s_mov_b64 exec, s[56:57]
  v_cmp_eq_u32 vcc, v10, v155
  s_nop 0
  s_andn2_b64 s[56:57], s[56:57], vcc
  s_mov_b64 exec, vcc
  v_mov_b32 v76, v152
  v_mov_b32 v77, v153
  v_mov_b32 v78, v154
  s_mov_b64 exec, s[58:59]
  v_cmp_eq_u32 vcc, v10, v159
  s_nop 0
  s_andn2_b64 s[58:59], s[58:59], vcc
  s_mov_b64 exec, vcc
  v_mov_b32 v80, v156
  v_mov_b32 v81, v157
  v_mov_b32 v82, v158
  s_mov_b64 exec, s[60:61]
  v_cmp_eq_u32 vcc, v10, v163
  s_nop 0
  s_andn2_b64 s[60:61], s[60:61], vcc
  s_mov_b64 exec, vcc
  v_mov_b32 v84, v160
  v_mov_b32 v85, v161
  v_mov_b32 v86, v162
  s_cmp_eq_u64 s[56:57], 0
  s_cselect_b64 exec, 1, s[56:57]
  global_load_dwordx4 v[152:155], v146, s[40:41] offset:0 sc1
  s_cmp_eq_u64 s[58:59], 0
  s_cselect_b64 exec, 1, s[58:59]
  global_load_dwordx4 v[156:159], v147, s[40:41] offset:0 sc1
  s_cmp_eq_u64 s[60:61], 0
  s_cselect_b64 exec, 1, s[60:61]
  global_load_dwordx4 v[160:163], v148, s[40:41] offset:0 sc1
  s_cmp_eq_u64 s[62:63], 0
  s_cselect_b64 exec, 1, s[62:63]
  global_load_dwordx4 v[164:167], v17, s[40:41] offset:0 sc1
  s_cmp_lg_u32 s66, 0
  s_cbranch_scc1 L_fpk_28_g
  s_or_b64 s[54:55], s[56:57], s[58:59]
  s_or_b64 s[54:55], s[54:55], s[60:61]
  s_cmp_eq_u64 s[54:55], 0
  s_cbranch_scc0 L_fpk_28
  s_mov_b64 exec, -1
  v_perm_b32 v79, v76, v77, s39
  v_perm_b32 v79, v79, v78, s15
  v_perm_b32 v83, v80, v81, s39
  v_perm_b32 v83, v83, v82, s15
  v_perm_b32 v87, v84, v85, s39
  v_perm_b32 v87, v87, v86, s15
  v_add_f32 v76, v76, v80
  v_add_f32 v77, v77, v81
  v_add_f32 v78, v78, v82
  v_add_f32 v79, v79, v83
  v_add_f32 v76, v76, v84
  v_add_f32 v77, v77, v85
  v_add_f32 v78, v78, v86
  v_add_f32 v79, v79, v87
  v_cndmask_b32 v28, v76, v77, s[48:49]
  v_cndmask_b32 v29, v77, v76, s[48:49]
  v_cndmask_b32 v30, v78, v79, s[48:49]
  v_cndmask_b32 v31, v79, v78, s[48:49]
  s_nop 0
  v_add_f32_dpp v28, v29, v28 quad_perm:[2,3,0,1] row_mask:0xf bank_mask:0xf
  v_add_f32_dpp v30, v31, v30 quad_perm:[2,3,0,1] row_mask:0xf bank_mask:0xf
  s_nop 0
  v_cndmask_b32 v140, v28, v30, s[50:51]
  v_cndmask_b32 v33, v30, v28, s[50:51]
  s_nop 1
  v_add_f32_dpp v140, v33, v140 row_ror:4 row_mask:0xf bank_mask:0xf
  s_nop 1
  v_add_f32_dpp v140, v140, v140 row_ror:8 row_mask:0xf bank_mask:0xf
  v_mov_b32 v33, v140
  s_nop 1
  v_permlane16_swap_b32 v140, v33
  s_nop 0
  v_add_f32 v140, v140, v33
  v_mov_b32 v33, v140
  s_nop 1
  v_permlane32_swap_b32 v140, v33
  s_nop 0
  v_add_f32 v140, v140, v33
  v_cvt_pk_bf16_f32 v140, v140, v140
  v_and_b32 v140, 0xffff0000, v140
  v_add_f32 v140, v140, v12
  v_cvt_pk_bf16_f32 v140, v140, v140
  v_and_b32 v140, 0xffff0000, v140
  v_mul_f32 v20, 0xbfb8aa3b, v140
  v_exp_f32 v20, v20
  s_nop 0
  v_add_f32 v20, 1.0, v20
  v_rcp_f32 v20, v20
  s_nop 0
  v_mul_f32 v140, v140, v20
  v_cvt_pk_bf16_f32 v140, v140, v140
  v_and_b32 v140, 0xffff0000, v140
  s_mov_b32 s66, 1
L_fpk_28_g:
  s_cmp_eq_u64 s[62:63], 0
  s_cbranch_scc1 L_fpd_27
L_fpk_28:
  s_waitcnt vmcnt(4)
  s_mov_b64 exec, s[62:63]
  v_cmp_eq_u32 vcc, v10, v183
  s_nop 0
  s_andn2_b64 s[62:63], s[62:63], vcc
  s_mov_b64 exec, vcc
  v_mov_b32 v92, v180
  v_mov_b32 v93, v181
  v_mov_b32 v94, v182
  s_mov_b64 exec, s[56:57]
  v_cmp_eq_u32 vcc, v10, v171
  s_nop 0
  s_andn2_b64 s[56:57], s[56:57], vcc
  s_mov_b64 exec, vcc
  v_mov_b32 v76, v168
  v_mov_b32 v77, v169
  v_mov_b32 v78, v170
  s_mov_b64 exec, s[58:59]
  v_cmp_eq_u32 vcc, v10, v175
  s_nop 0
  s_andn2_b64 s[58:59], s[58:59], vcc
  s_mov_b64 exec, vcc
  v_mov_b32 v80, v172
  v_mov_b32 v81, v173
  v_mov_b32 v82, v174
  s_mov_b64 exec, s[60:61]
  v_cmp_eq_u32 vcc, v10, v179
  s_nop 0
  s_andn2_b64 s[60:61], s[60:61], vcc
  s_mov_b64 exec, vcc
  v_mov_b32 v84, v176
  v_mov_b32 v85, v177
  v_mov_b32 v86, v178
  s_cmp_eq_u64 s[56:57], 0
  s_cselect_b64 exec, 1, s[56:57]
  global_load_dwordx4 v[168:171], v146, s[40:41] offset:0 sc1
  s_cmp_eq_u64 s[58:59], 0
  s_cselect_b64 exec, 1, s[58:59]
  global_load_dwordx4 v[172:175], v147, s[40:41] offset:0 sc1
  s_cmp_eq_u64 s[60:61], 0
  s_cselect_b64 exec, 1, s[60:61]
  global_load_dwordx4 v[176:179], v148, s[40:41] offset:0 sc1
  s_cmp_eq_u64 s[62:63], 0
  s_cselect_b64 exec, 1, s[62:63]
  global_load_dwordx4 v[180:183], v17, s[40:41] offset:0 sc1
  s_cmp_lg_u32 s66, 0
  s_cbranch_scc1 L_fpk_29_g
  s_or_b64 s[54:55], s[56:57], s[58:59]
  s_or_b64 s[54:55], s[54:55], s[60:61]
  s_cmp_eq_u64 s[54:55], 0
  s_cbranch_scc0 L_fpk_29
  s_mov_b64 exec, -1
  v_perm_b32 v79, v76, v77, s39
  v_perm_b32 v79, v79, v78, s15
  v_perm_b32 v83, v80, v81, s39
  v_perm_b32 v83, v83, v82, s15
  v_perm_b32 v87, v84, v85, s39
  v_perm_b32 v87, v87, v86, s15
  v_add_f32 v76, v76, v80
  v_add_f32 v77, v77, v81
  v_add_f32 v78, v78, v82
  v_add_f32 v79, v79, v83
  v_add_f32 v76, v76, v84
  v_add_f32 v77, v77, v85
  v_add_f32 v78, v78, v86
  v_add_f32 v79, v79, v87
  v_cndmask_b32 v28, v76, v77, s[48:49]
  v_cndmask_b32 v29, v77, v76, s[48:49]
  v_cndmask_b32 v30, v78, v79, s[48:49]
  v_cndmask_b32 v31, v79, v78, s[48:49]
  s_nop 0
  v_add_f32_dpp v28, v29, v28 quad_perm:[2,3,0,1] row_mask:0xf bank_mask:0xf
  v_add_f32_dpp v30, v31, v30 quad_perm:[2,3,0,1] row_mask:0xf bank_mask:0xf
  s_nop 0
  v_cndmask_b32 v140, v28, v30, s[50:51]
  v_cndmask_b32 v33, v30, v28, s[50:51]
  s_nop 1
  v_add_f32_dpp v140, v33, v140 row_ror:4 row_mask:0xf bank_mask:0xf
  s_nop 1
  v_add_f32_dpp v140, v140, v140 row_ror:8 row_mask:0xf bank_mask:0xf
  v_mov_b32 v33, v140
  s_nop 1
  v_permlane16_swap_b32 v140, v33
  s_nop 0
  v_add_f32 v140, v140, v33
  v_mov_b32 v33, v140
  s_nop 1
  v_permlane32_swap_b32 v140, v33
  s_nop 0
  v_add_f32 v140, v140, v33
  v_cvt_pk_bf16_f32 v140, v140, v140
  v_and_b32 v140, 0xffff0000, v140
  v_add_f32 v140, v140, v12
  v_cvt_pk_bf16_f32 v140, v140, v140
  v_and_b32 v140, 0xffff0000, v140
  v_mul_f32 v20, 0xbfb8aa3b, v140
  v_exp_f32 v20, v20
  s_nop 0
  v_add_f32 v20, 1.0, v20
  v_rcp_f32 v20, v20
  s_nop 0
  v_mul_f32 v140, v140, v20
  v_cvt_pk_bf16_f32 v140, v140, v140
  v_and_b32 v140, 0xffff0000, v140
  s_mov_b32 s66, 1
L_fpk_29_g:
  s_cmp_eq_u64 s[62:63], 0
  s_cbranch_scc1 L_fpd_27
L_fpk_29:
  s_sub_u32 s52, s52, 1
  s_cmp_lg_u32 s52, 0
  s_cbranch_scc1 L_fp_26
L_fpd_27:
  s_mov_b64 exec, -1
  v_perm_b32 v95, v92, v93, s39
  v_perm_b32 v95, v95, v94, s15
  v_cndmask_b32 v28, v92, v93, s[48:49]
  v_cndmask_b32 v29, v93, v92, s[48:49]
  v_cndmask_b32 v30, v94, v95, s[48:49]
  v_cndmask_b32 v31, v95, v94, s[48:49]
  s_nop 0
  v_add_f32_dpp v28, v29, v28 quad_perm:[2,3,0,1] row_mask:0xf bank_mask:0xf
  v_add_f32_dpp v30, v31, v30 quad_perm:[2,3,0,1] row_mask:0xf bank_mask:0xf
  s_nop 0
  v_cndmask_b32 v24, v28, v30, s[50:51]
  v_cndmask_b32 v33, v30, v28, s[50:51]
  s_nop 1
  v_add_f32_dpp v24, v33, v24 row_ror:4 row_mask:0xf bank_mask:0xf
  s_nop 1
  v_add_f32_dpp v24, v24, v24 row_ror:8 row_mask:0xf bank_mask:0xf
  v_mov_b32 v33, v24
  s_nop 1
  v_permlane16_swap_b32 v24, v33
  s_nop 0
  v_add_f32 v24, v24, v33
  v_mov_b32 v33, v24
  s_nop 1
  v_permlane32_swap_b32 v24, v33
  s_nop 0
  v_add_f32 v24, v24, v33
  v_cvt_pk_bf16_f32 v24, v24, v24
  v_and_b32 v24, 0xffff0000, v24
  v_mul_f32 v24, v24, v140
  v_cvt_pk_bf16_f32 v24, v24, v24
  v_and_b32 v24, 0xffff0000, v24
  v_add_f32 v24, v24, v13
  v_cvt_pk_bf16_f32 v24, v24, v24
  s_mov_b64 exec, 0xff
  buffer_store_short v24, v141, s[44:47], 0 offen sc1
  s_cmp_lg_u32 s2, 0
  s_cbranch_scc1 L_fin
  s_mov_b64 exec, 1
  v_mov_b32 v20, 0
  global_store_dword v20, v10, s[40:41] sc1
  s_branch L_fin
L_code_end:
.section .rodata,"a"
.p2align 6
.amdhsa_kernel recurrent_scan__mha_block_cached__dense_activation_squared_relu__decode_kernel
  .amdhsa_next_free_vgpr 248
  .amdhsa_next_free_sgpr 102
  .amdhsa_accum_offset 248
  .amdhsa_group_segment_fixed_size 0
  .amdhsa_kernarg_size 104
  .amdhsa_user_sgpr_count 2
  .amdhsa_user_sgpr_kernarg_segment_ptr 1
  .amdhsa_system_sgpr_workgroup_id_x 1
.end_amdhsa_kernel
```
